```python
import torch

def _softmax(x, axis=-1):
    return torch.softmax(x, dim=axis)
def _gelu(x):
    return torch.nn.functional.gelu(x, approximate="tanh")
def _silu(x):
    return torch.nn.functional.silu(x)
def _sigmoid(x):
    return torch.sigmoid(x)
def _layernorm(x, axis=-1, eps=1e-5):
    m = x.mean(dim=axis, keepdim=True)
    v = x.var(dim=axis, keepdim=True, unbiased=False)
    return (x - m) / torch.sqrt(v + eps)
def _scatter_add(tgt, idx, src, axis=0):
    return tgt.clone().index_add_(axis, idx, src)
def _segment_sum(src, seg, n):
    out = torch.zeros((n,) + src.shape[1:], dtype=src.dtype)
    return out.index_add_(0, seg, src)
def _pad(x, pw):
    flat = tuple(v for pair in reversed(pw) for v in pair)
    return torch.nn.functional.pad(x, flat)

kernel_name = 'standalone__gqa_block_cached__decode'

def setup_inputs():

    _w = (lambda a: (lambda t: t.to(torch.bfloat16) if t.is_floating_point() else t)(torch.as_tensor(a)))
    B, Sq, D = 1, 1, 640
    Hq, Hkv, Sk, Dh = 32, 32, 32768, 128
    assert Hq % Hkv == 0, (Hq, Hkv)
    return {
        "x": _w((lambda *s: torch.randn(*s, dtype=torch.bfloat16) * 0.8)(B, Sq, D)),
        "k_cache": _w((lambda *s: torch.randn(*s, dtype=torch.bfloat16) * 0.8)(B, Hkv, Sk, Dh)),
        "v_cache": _w((lambda *s: torch.randn(*s, dtype=torch.bfloat16) * 0.05)(B, Hkv, Sk, Dh)),
        "wq": _w((lambda *s: torch.randn(*s, dtype=torch.bfloat16) * 0.8)(D, Hq * Dh) * (D ** -0.5)),
        "wo": _w((lambda *s: torch.randn(*s, dtype=torch.bfloat16) * 0.05)(Hq * Dh, D) * ((Hq * Dh) ** -0.5)),
    }

def reference(x, k_cache, v_cache, wq, wo):
    B, Sq, D = x.shape
    Hq, Dh = 32, 128
    Hkv = k_cache.shape[1]
    rep = Hq // Hkv
    q = (lambda x, *d: x.permute(*d))((x @ wq).reshape(B, Sq, Hq, Dh), 0, 2, 1, 3)
    k = (lambda x, n, axis: torch.repeat_interleave(x, n, dim=axis))(k_cache, rep, axis=1)
    v = (lambda x, n, axis: torch.repeat_interleave(x, n, dim=axis))(v_cache, rep, axis=1)
    scores = torch.einsum("bhqd,bhkd->bhqk", q, k) * (Dh ** -0.5)
    p = _softmax(scores, axis=-1)
    o = torch.einsum("bhqk,bhkd->bhqd", p, v)
    return (lambda x, *d: x.permute(*d))(o, 0, 2, 1, 3).reshape(B, Sq, Hq * Dh) @ wo
```

```asm
; @launch grid=(256,1,1) block=(256,1,1) lds=28672
.amdgcn_target "amdgcn-amd-amdhsa--gfx950"
.text
.globl standalone__gqa_block_cached__decode_kernel
.p2align 8
.type standalone__gqa_block_cached__decode_kernel,@function
standalone__gqa_block_cached__decode_kernel:
  s_cmp_ge_u32 s2, 256
  s_cbranch_scc1 L_end
  s_load_dwordx16 s[4:19], s[0:1], 0
  v_and_b32 v1, 63, v0
  v_lshrrev_b32 v101, 6, v0
  s_lshr_b32 s48, s2, 3
  s_and_b32 s49, s2, 7
  v_readfirstlane_b32 s50, v101
  v_lshrrev_b32 v99, 4, v1
  v_and_b32 v100, 15, v1
  v_lshl_add_u32 v108, v100, 2, v99
  v_lshlrev_b32 v108, 1, v108
  v_lshlrev_b32 v109, 13, v99
  v_lshl_add_u32 v109, v100, 4, v109
  s_mov_b32 s42, 1280
  s_mov_b32 s43, 0x20000
  s_mov_b32 s30, 5242880
  s_mov_b32 s31, 0x20000
  s_mul_i32 s53, s49, 160
  s_mul_i32 s54, s49, 655360
  s_lshl_b32 s58, s48, 8
  s_add_u32 s54, s54, s58
  s_cmp_lg_u32 s50, 0
  s_cbranch_scc1 L_setup
  s_setprio 3
  s_waitcnt lgkmcnt(0)
  s_mov_b32 s40, s4
  s_mov_b32 s41, s5
  s_mov_b32 s28, s10
  s_mov_b32 s29, s11
  s_load_dword s3, s[18:19], 983040
  buffer_load_ushort v110, v108, s[40:43], s53 offen
  buffer_load_ushort v111, v108, s[40:43], s53 offen offset:128
  buffer_load_dwordx4 a[64:67], v109, s[28:31], s54 offen nt
  s_add_u32 s54, s54, 32768
  buffer_load_dwordx4 a[68:71], v109, s[28:31], s54 offen nt
  s_add_u32 s54, s54, 32768
  buffer_load_dwordx4 a[72:75], v109, s[28:31], s54 offen nt
  s_add_u32 s54, s54, 32768
  buffer_load_dwordx4 a[76:79], v109, s[28:31], s54 offen nt
  s_add_u32 s54, s54, 32768
  buffer_load_dwordx4 a[80:83], v109, s[28:31], s54 offen nt
  s_add_u32 s54, s54, 32768
  buffer_load_dwordx4 a[84:87], v109, s[28:31], s54 offen nt
  s_add_u32 s54, s54, 32768
  buffer_load_dwordx4 a[88:91], v109, s[28:31], s54 offen nt
  s_add_u32 s54, s54, 32768
  buffer_load_dwordx4 a[92:95], v109, s[28:31], s54 offen nt
  s_add_u32 s54, s54, 32768
  buffer_load_dwordx4 a[96:99], v109, s[28:31], s54 offen nt
  s_add_u32 s54, s54, 32768
  buffer_load_dwordx4 a[100:103], v109, s[28:31], s54 offen nt
  s_add_u32 s54, s54, 32768
  buffer_load_dwordx4 a[104:107], v109, s[28:31], s54 offen nt
  s_add_u32 s54, s54, 32768
  buffer_load_dwordx4 a[108:111], v109, s[28:31], s54 offen nt
  s_add_u32 s54, s54, 32768
  buffer_load_dwordx4 a[112:115], v109, s[28:31], s54 offen nt
  s_add_u32 s54, s54, 32768
  buffer_load_dwordx4 a[116:119], v109, s[28:31], s54 offen nt
  s_add_u32 s54, s54, 32768
  buffer_load_dwordx4 a[120:123], v109, s[28:31], s54 offen nt
  s_add_u32 s54, s54, 32768
  buffer_load_dwordx4 a[124:127], v109, s[28:31], s54 offen nt
  s_add_u32 s54, s54, 32768
  buffer_load_dwordx4 a[128:131], v109, s[28:31], s54 offen nt
  s_add_u32 s54, s54, 32768
  buffer_load_dwordx4 a[132:135], v109, s[28:31], s54 offen nt
  s_add_u32 s54, s54, 32768
  buffer_load_dwordx4 a[136:139], v109, s[28:31], s54 offen nt
  s_add_u32 s54, s54, 32768
  buffer_load_dwordx4 a[140:143], v109, s[28:31], s54 offen nt
L_setup:
  v_lshlrev_b32 v3, 4, v1
  v_lshl_add_u32 v3, v101, 12, v3
  v_bfe_u32 v104, v1, 2, 2
  v_and_b32 v105, 3, v1
  v_lshlrev_b32 v2, 8, v104
  v_lshl_add_u32 v2, v99, 6, v2
  v_lshl_add_u32 v2, v105, 4, v2
  v_lshl_add_u32 v2, v101, 12, v2
  v_mov_b32 v102, v2
  v_mov_b32 v103, v2
  s_lshl_b32 s57, s48, 23
  s_mov_b32 s22, 8388608
  s_mov_b32 s23, 0x20000
  s_mov_b32 s26, 8388608
  s_mov_b32 s27, 0x20000
  s_lshr_b32 s53, s49, 1
  s_lshl_b32 s53, s53, 21
  s_and_b32 s58, s49, 1
  s_lshl_b32 s58, s58, 16
  s_or_b32 s53, s53, s58
  s_mov_b32 s75, s53
  s_mov_b32 s74, 16384
  s_mov_b32 s38, 1048576
  s_mov_b32 s39, 0x20000
  s_cmp_lt_u32 s49, 5
  s_cselect_b32 s34, 5242880, 0
  s_mov_b32 s35, 0x20000
  s_mul_i32 s55, s48, 256
  s_add_u32 s55, s55, 524288
  s_mul_i32 s70, s48, 5120
  s_add_u32 s70, s70, 131072
  s_mov_b32 s68, 0xc0faf233
  s_mov_b32 s69, 0xbe0293ee
  s_mov_b32 s60, 0xf000f
  s_mov_b32 s61, 0xf000f
  s_mov_b32 s62, 0xf000f0
  s_mov_b32 s63, 0xf000f0
  s_mov_b32 s64, 0xf000f00
  s_mov_b32 s65, 0xf000f00
  s_mov_b32 s66, 0xf000f000
  s_mov_b32 s67, 0xf000f000
  s_mov_b32 s72, 0
  s_mov_b32 s73, -1
  v_and_b32 v104, 1, v1
  v_lshlrev_b32 v104, 4, v104
  v_mov_b32 v105, 0xffff
  v_lshlrev_b32 v105, v104, v105
  v_lshrrev_b32 v106, 1, v100
  v_cmp_eq_u32 s[84:85], 0, v106
  v_cmp_eq_u32 s[86:87], 1, v106
  v_cmp_eq_u32 s[88:89], 2, v106
  v_cmp_eq_u32 s[90:91], 3, v106
  v_mov_b32 v62, 0xff
  v_mov_b32 v61, 0
  v_cndmask_b32 v8, 0, v105, s[84:85]
  v_cndmask_b32 v9, 0, v105, s[86:87]
  v_cndmask_b32 v10, 0, v105, s[88:89]
  v_cndmask_b32 v11, 0, v105, s[90:91]
  v_lshlrev_b32 v104, 5, v100
  v_lshl_add_u32 v104, v99, 4, v104
  v_mov_b32 v105, 0x40000000
  v_cndmask_b32 v97, v104, v105, s[72:73]
  v_cmp_eq_u32 vcc, 32, v1
  v_mov_b32 v106, 0x200
  v_mov_b32 v4, 0x3e0293ee
  v_cndmask_b32 v98, v97, v106, vcc
  v_mov_b32 v12, 0
  v_mov_b32 v13, 0
  v_mov_b32 v14, 0
  v_mov_b32 v15, 0
  v_mov_b32 v20, 0
  v_mov_b32 v21, 0
  v_mov_b32 v22, 0
  v_mov_b32 v23, 0
  v_mov_b32 v56, 0
  v_mov_b32 v96, 0
  v_lshl_add_u32 v107, v101, 2, v99
  v_mul_u32_u24 v107, 10240, v107
  v_lshl_add_u32 v107, v100, 4, v107
  s_cmp_eq_u32 s50, 0
  s_cbranch_scc1 L_setup1
  s_waitcnt lgkmcnt(0)
  s_load_dword s3, s[18:19], 983040
L_setup1:
  s_add_u32 s6, s6, s57
  s_addc_u32 s7, s7, 0
  s_mov_b64 s[20:21], s[6:7]
  s_mov_b64 s[24:25], s[6:7]
  s_add_u32 s8, s8, s57
  s_addc_u32 s9, s9, 0
  s_mov_b32 s32, s12
  s_mov_b32 s33, s13
  s_mov_b32 s36, s18
  s_mov_b32 s37, s19
  s_cmp_lg_u32 s50, 0
  s_cbranch_scc1 L_w123
  v_or_b32 v106, s49, v1
  v_lshlrev_b32 v106, 24, v106
  buffer_store_dword v12, v106, s[36:39], s55 offen sc1
  v_bfe_u32 v108, v1, 2, 2
  v_lshlrev_b32 v108, 10, v108
  v_lshl_add_u32 v108, v99, 7, v108
  v_and_b32 v109, 3, v1
  v_lshl_add_u32 v108, v109, 5, v108
  s_lshl_b32 s54, s48, 12
  s_mov_b32 s59, 100000
  s_waitcnt vmcnt(20)
  v_lshl_or_b32 v110, v110, 16, v110
  v_lshl_or_b32 v111, v111, 16, v111
  s_nop 1
  v_and_b32_dpp v40, v110, v8 row_newbcast:0 row_mask:0xf bank_mask:0xf
  v_and_b32_dpp v41, v110, v9 row_newbcast:0 row_mask:0xf bank_mask:0xf
  v_and_b32_dpp v42, v110, v10 row_newbcast:0 row_mask:0xf bank_mask:0xf
  v_and_b32_dpp v43, v110, v11 row_newbcast:0 row_mask:0xf bank_mask:0xf
  s_waitcnt vmcnt(19)
  s_nop 0
  v_mfma_f32_16x16x32_bf16 v[16:19], v[40:43], a[64:67], 0
  v_and_b32_dpp v44, v110, v8 row_newbcast:1 row_mask:0xf bank_mask:0xf
  v_and_b32_dpp v45, v110, v9 row_newbcast:1 row_mask:0xf bank_mask:0xf
  v_and_b32_dpp v46, v110, v10 row_newbcast:1 row_mask:0xf bank_mask:0xf
  v_and_b32_dpp v47, v110, v11 row_newbcast:1 row_mask:0xf bank_mask:0xf
  s_waitcnt vmcnt(18)
  s_nop 0
  v_mfma_f32_16x16x32_bf16 v[16:19], v[44:47], a[68:71], v[16:19]
  v_and_b32_dpp v48, v110, v8 row_newbcast:2 row_mask:0xf bank_mask:0xf
  v_and_b32_dpp v49, v110, v9 row_newbcast:2 row_mask:0xf bank_mask:0xf
  v_and_b32_dpp v50, v110, v10 row_newbcast:2 row_mask:0xf bank_mask:0xf
  v_and_b32_dpp v51, v110, v11 row_newbcast:2 row_mask:0xf bank_mask:0xf
  s_waitcnt vmcnt(17)
  s_nop 0
  v_mfma_f32_16x16x32_bf16 v[16:19], v[48:51], a[72:75], v[16:19]
  v_and_b32_dpp v52, v110, v8 row_newbcast:3 row_mask:0xf bank_mask:0xf
  v_and_b32_dpp v53, v110, v9 row_newbcast:3 row_mask:0xf bank_mask:0xf
  v_and_b32_dpp v54, v110, v10 row_newbcast:3 row_mask:0xf bank_mask:0xf
  v_and_b32_dpp v55, v110, v11 row_newbcast:3 row_mask:0xf bank_mask:0xf
  s_waitcnt vmcnt(16)
  s_nop 0
  v_mfma_f32_16x16x32_bf16 v[16:19], v[52:55], a[76:79], v[16:19]
  v_and_b32_dpp v40, v110, v8 row_newbcast:4 row_mask:0xf bank_mask:0xf
  v_and_b32_dpp v41, v110, v9 row_newbcast:4 row_mask:0xf bank_mask:0xf
  v_and_b32_dpp v42, v110, v10 row_newbcast:4 row_mask:0xf bank_mask:0xf
  v_and_b32_dpp v43, v110, v11 row_newbcast:4 row_mask:0xf bank_mask:0xf
  s_waitcnt vmcnt(15)
  s_nop 0
  v_mfma_f32_16x16x32_bf16 v[16:19], v[40:43], a[80:83], v[16:19]
  v_and_b32_dpp v44, v110, v8 row_newbcast:5 row_mask:0xf bank_mask:0xf
  v_and_b32_dpp v45, v110, v9 row_newbcast:5 row_mask:0xf bank_mask:0xf
  v_and_b32_dpp v46, v110, v10 row_newbcast:5 row_mask:0xf bank_mask:0xf
  v_and_b32_dpp v47, v110, v11 row_newbcast:5 row_mask:0xf bank_mask:0xf
  s_waitcnt vmcnt(14)
  s_nop 0
  v_mfma_f32_16x16x32_bf16 v[16:19], v[44:47], a[84:87], v[16:19]
  v_and_b32_dpp v48, v110, v8 row_newbcast:6 row_mask:0xf bank_mask:0xf
  v_and_b32_dpp v49, v110, v9 row_newbcast:6 row_mask:0xf bank_mask:0xf
  v_and_b32_dpp v50, v110, v10 row_newbcast:6 row_mask:0xf bank_mask:0xf
  v_and_b32_dpp v51, v110, v11 row_newbcast:6 row_mask:0xf bank_mask:0xf
  s_waitcnt vmcnt(13)
  s_nop 0
  v_mfma_f32_16x16x32_bf16 v[16:19], v[48:51], a[88:91], v[16:19]
  v_and_b32_dpp v52, v110, v8 row_newbcast:7 row_mask:0xf bank_mask:0xf
  v_and_b32_dpp v53, v110, v9 row_newbcast:7 row_mask:0xf bank_mask:0xf
  v_and_b32_dpp v54, v110, v10 row_newbcast:7 row_mask:0xf bank_mask:0xf
  v_and_b32_dpp v55, v110, v11 row_newbcast:7 row_mask:0xf bank_mask:0xf
  s_waitcnt vmcnt(12)
  s_nop 0
  v_mfma_f32_16x16x32_bf16 v[16:19], v[52:55], a[92:95], v[16:19]
  v_and_b32_dpp v40, v110, v8 row_newbcast:8 row_mask:0xf bank_mask:0xf
  v_and_b32_dpp v41, v110, v9 row_newbcast:8 row_mask:0xf bank_mask:0xf
  v_and_b32_dpp v42, v110, v10 row_newbcast:8 row_mask:0xf bank_mask:0xf
  v_and_b32_dpp v43, v110, v11 row_newbcast:8 row_mask:0xf bank_mask:0xf
  s_waitcnt vmcnt(11)
  s_nop 0
  v_mfma_f32_16x16x32_bf16 v[16:19], v[40:43], a[96:99], v[16:19]
  v_and_b32_dpp v44, v110, v8 row_newbcast:9 row_mask:0xf bank_mask:0xf
  v_and_b32_dpp v45, v110, v9 row_newbcast:9 row_mask:0xf bank_mask:0xf
  v_and_b32_dpp v46, v110, v10 row_newbcast:9 row_mask:0xf bank_mask:0xf
  v_and_b32_dpp v47, v110, v11 row_newbcast:9 row_mask:0xf bank_mask:0xf
  s_waitcnt vmcnt(10)
  s_nop 0
  v_mfma_f32_16x16x32_bf16 v[16:19], v[44:47], a[100:103], v[16:19]
  v_and_b32_dpp v48, v110, v8 row_newbcast:10 row_mask:0xf bank_mask:0xf
  v_and_b32_dpp v49, v110, v9 row_newbcast:10 row_mask:0xf bank_mask:0xf
  v_and_b32_dpp v50, v110, v10 row_newbcast:10 row_mask:0xf bank_mask:0xf
  v_and_b32_dpp v51, v110, v11 row_newbcast:10 row_mask:0xf bank_mask:0xf
  s_waitcnt vmcnt(9)
  s_nop 0
  v_mfma_f32_16x16x32_bf16 v[16:19], v[48:51], a[104:107], v[16:19]
  v_and_b32_dpp v52, v110, v8 row_newbcast:11 row_mask:0xf bank_mask:0xf
  v_and_b32_dpp v53, v110, v9 row_newbcast:11 row_mask:0xf bank_mask:0xf
  v_and_b32_dpp v54, v110, v10 row_newbcast:11 row_mask:0xf bank_mask:0xf
  v_and_b32_dpp v55, v110, v11 row_newbcast:11 row_mask:0xf bank_mask:0xf
  s_waitcnt vmcnt(8)
  s_nop 0
  v_mfma_f32_16x16x32_bf16 v[16:19], v[52:55], a[108:111], v[16:19]
  v_and_b32_dpp v40, v110, v8 row_newbcast:12 row_mask:0xf bank_mask:0xf
  v_and_b32_dpp v41, v110, v9 row_newbcast:12 row_mask:0xf bank_mask:0xf
  v_and_b32_dpp v42, v110, v10 row_newbcast:12 row_mask:0xf bank_mask:0xf
  v_and_b32_dpp v43, v110, v11 row_newbcast:12 row_mask:0xf bank_mask:0xf
  s_waitcnt vmcnt(7)
  s_nop 0
  v_mfma_f32_16x16x32_bf16 v[16:19], v[40:43], a[112:115], v[16:19]
  v_and_b32_dpp v44, v110, v8 row_newbcast:13 row_mask:0xf bank_mask:0xf
  v_and_b32_dpp v45, v110, v9 row_newbcast:13 row_mask:0xf bank_mask:0xf
  v_and_b32_dpp v46, v110, v10 row_newbcast:13 row_mask:0xf bank_mask:0xf
  v_and_b32_dpp v47, v110, v11 row_newbcast:13 row_mask:0xf bank_mask:0xf
  s_waitcnt vmcnt(6)
  s_nop 0
  v_mfma_f32_16x16x32_bf16 v[16:19], v[44:47], a[116:119], v[16:19]
  v_and_b32_dpp v48, v110, v8 row_newbcast:14 row_mask:0xf bank_mask:0xf
  v_and_b32_dpp v49, v110, v9 row_newbcast:14 row_mask:0xf bank_mask:0xf
  v_and_b32_dpp v50, v110, v10 row_newbcast:14 row_mask:0xf bank_mask:0xf
  v_and_b32_dpp v51, v110, v11 row_newbcast:14 row_mask:0xf bank_mask:0xf
  s_waitcnt vmcnt(5)
  s_nop 0
  v_mfma_f32_16x16x32_bf16 v[16:19], v[48:51], a[120:123], v[16:19]
  v_and_b32_dpp v52, v110, v8 row_newbcast:15 row_mask:0xf bank_mask:0xf
  v_and_b32_dpp v53, v110, v9 row_newbcast:15 row_mask:0xf bank_mask:0xf
  v_and_b32_dpp v54, v110, v10 row_newbcast:15 row_mask:0xf bank_mask:0xf
  v_and_b32_dpp v55, v110, v11 row_newbcast:15 row_mask:0xf bank_mask:0xf
  s_waitcnt vmcnt(4)
  s_nop 0
  v_mfma_f32_16x16x32_bf16 v[16:19], v[52:55], a[124:127], v[16:19]
  v_and_b32_dpp v40, v111, v8 row_newbcast:0 row_mask:0xf bank_mask:0xf
  v_and_b32_dpp v41, v111, v9 row_newbcast:0 row_mask:0xf bank_mask:0xf
  v_and_b32_dpp v42, v111, v10 row_newbcast:0 row_mask:0xf bank_mask:0xf
  v_and_b32_dpp v43, v111, v11 row_newbcast:0 row_mask:0xf bank_mask:0xf
  s_waitcnt vmcnt(3)
  s_nop 0
  v_mfma_f32_16x16x32_bf16 v[16:19], v[40:43], a[128:131], v[16:19]
  v_and_b32_dpp v44, v111, v8 row_newbcast:1 row_mask:0xf bank_mask:0xf
  v_and_b32_dpp v45, v111, v9 row_newbcast:1 row_mask:0xf bank_mask:0xf
  v_and_b32_dpp v46, v111, v10 row_newbcast:1 row_mask:0xf bank_mask:0xf
  v_and_b32_dpp v47, v111, v11 row_newbcast:1 row_mask:0xf bank_mask:0xf
  s_waitcnt vmcnt(2)
  s_nop 0
  v_mfma_f32_16x16x32_bf16 v[16:19], v[44:47], a[132:135], v[16:19]
  v_and_b32_dpp v48, v111, v8 row_newbcast:2 row_mask:0xf bank_mask:0xf
  v_and_b32_dpp v49, v111, v9 row_newbcast:2 row_mask:0xf bank_mask:0xf
  v_and_b32_dpp v50, v111, v10 row_newbcast:2 row_mask:0xf bank_mask:0xf
  v_and_b32_dpp v51, v111, v11 row_newbcast:2 row_mask:0xf bank_mask:0xf
  s_waitcnt vmcnt(1)
  s_nop 0
  v_mfma_f32_16x16x32_bf16 v[16:19], v[48:51], a[136:139], v[16:19]
  v_and_b32_dpp v52, v111, v8 row_newbcast:3 row_mask:0xf bank_mask:0xf
  v_and_b32_dpp v53, v111, v9 row_newbcast:3 row_mask:0xf bank_mask:0xf
  v_and_b32_dpp v54, v111, v10 row_newbcast:3 row_mask:0xf bank_mask:0xf
  v_and_b32_dpp v55, v111, v11 row_newbcast:3 row_mask:0xf bank_mask:0xf
  s_waitcnt vmcnt(0)
  s_nop 0
  v_mfma_f32_16x16x32_bf16 v[16:19], v[52:55], a[140:143], v[16:19]
  s_lshl_b32 s57, s2, 9
  s_waitcnt lgkmcnt(0)
  s_add_u32 s3, s3, 1
  s_and_b32 s40, s3, 0xff
  s_nop 0
  s_nop 2
  v_bfi_b32 v16, v62, s40, v16
  v_bfi_b32 v17, v62, s40, v17
  v_bfi_b32 v18, v62, s40, v18
  v_bfi_b32 v19, v62, s40, v19
  buffer_store_dwordx4 v[16:19], v97, s[36:39], s57 offen sc1
  buffer_load_dwordx4 a[0:3], v102, s[20:23], s53 offen offset:0 nt
  buffer_load_dwordx4 a[4:7], v102, s[20:23], s53 offen offset:1024 nt
  buffer_load_dwordx4 a[8:11], v102, s[20:23], s53 offen offset:2048 nt
  buffer_load_dwordx4 a[12:15], v102, s[20:23], s53 offen offset:3072 nt
  s_add_u32 s53, s53, s74
  buffer_load_dwordx4 a[16:19], v103, s[24:27], s53 offen offset:0 nt
  buffer_load_dwordx4 a[20:23], v103, s[24:27], s53 offen offset:1024 nt
  buffer_load_dwordx4 a[24:27], v103, s[24:27], s53 offen offset:2048 nt
  buffer_load_dwordx4 a[28:31], v103, s[24:27], s53 offen offset:3072 nt
  s_add_u32 s53, s53, 16384
  buffer_load_dwordx4 a[32:35], v102, s[20:23], s53 offen offset:0 nt
  buffer_load_dwordx4 a[36:39], v102, s[20:23], s53 offen offset:1024 nt
  buffer_load_dwordx4 a[40:43], v102, s[20:23], s53 offen offset:2048 nt
  buffer_load_dwordx4 a[44:47], v102, s[20:23], s53 offen offset:3072 nt
  s_add_u32 s53, s53, 16384
  buffer_load_dwordx4 a[48:51], v103, s[24:27], s53 offen offset:0 nt
  buffer_load_dwordx4 a[52:55], v103, s[24:27], s53 offen offset:1024 nt
  buffer_load_dwordx4 a[56:59], v103, s[24:27], s53 offen offset:2048 nt
  buffer_load_dwordx4 a[60:63], v103, s[24:27], s53 offen offset:3072 nt
  s_add_u32 s53, s53, 81920
L_qpoll:
  buffer_load_dwordx4 v[112:115], v108, s[36:39], s54 offen sc1
  buffer_load_dwordx4 v[116:119], v108, s[36:39], s54 offen offset:16 sc1
  buffer_load_dwordx4 v[120:123], v108, s[36:39], s54 offen offset:512 sc1
  buffer_load_dwordx4 v[124:127], v108, s[36:39], s54 offen offset:528 sc1
  s_sub_u32 s59, s59, 1
  s_waitcnt vmcnt(0)
  s_cbranch_scc1 L_qgot
  v_xor_b32 v112, s40, v112
  v_xor_b32 v113, s40, v113
  v_xor_b32 v114, s40, v114
  v_xor_b32 v115, s40, v115
  v_xor_b32 v116, s40, v116
  v_xor_b32 v117, s40, v117
  v_xor_b32 v118, s40, v118
  v_xor_b32 v119, s40, v119
  v_xor_b32 v120, s40, v120
  v_xor_b32 v121, s40, v121
  v_xor_b32 v122, s40, v122
  v_xor_b32 v123, s40, v123
  v_xor_b32 v124, s40, v124
  v_xor_b32 v125, s40, v125
  v_xor_b32 v126, s40, v126
  v_xor_b32 v127, s40, v127
  v_or3_b32 v109, v112, v113, v114
  v_or3_b32 v109, v109, v115, v116
  v_or3_b32 v109, v109, v117, v118
  v_or3_b32 v109, v109, v119, v120
  v_or3_b32 v109, v109, v121, v122
  v_or3_b32 v109, v109, v123, v124
  v_or3_b32 v109, v109, v125, v126
  v_or_b32 v109, v109, v127
  v_and_b32 v109, v62, v109
  v_cmp_ne_u32 vcc, 0, v109
  s_cbranch_vccnz L_qpoll
L_qgot:
  v_lshlrev_b32 v104, 4, v1
  v_add_f32 v112, v112, v120
  v_add_f32 v113, v113, v121
  v_add_f32 v114, v114, v122
  v_add_f32 v115, v115, v123
  v_add_f32 v116, v116, v124
  v_add_f32 v117, v117, v125
  v_add_f32 v118, v118, v126
  v_add_f32 v119, v119, v127
  v_add_f32_dpp v112, v112, v112 row_ror:8 row_mask:0xf bank_mask:0xf
  v_add_f32_dpp v113, v113, v113 row_ror:8 row_mask:0xf bank_mask:0xf
  v_add_f32_dpp v114, v114, v114 row_ror:8 row_mask:0xf bank_mask:0xf
  v_add_f32_dpp v115, v115, v115 row_ror:8 row_mask:0xf bank_mask:0xf
  v_add_f32_dpp v116, v116, v116 row_ror:8 row_mask:0xf bank_mask:0xf
  v_add_f32_dpp v117, v117, v117 row_ror:8 row_mask:0xf bank_mask:0xf
  v_add_f32_dpp v118, v118, v118 row_ror:8 row_mask:0xf bank_mask:0xf
  v_add_f32_dpp v119, v119, v119 row_ror:8 row_mask:0xf bank_mask:0xf
  v_add_f32_dpp v112, v112, v112 row_ror:4 row_mask:0xf bank_mask:0xf
  v_add_f32_dpp v113, v113, v113 row_ror:4 row_mask:0xf bank_mask:0xf
  v_add_f32_dpp v114, v114, v114 row_ror:4 row_mask:0xf bank_mask:0xf
  v_add_f32_dpp v115, v115, v115 row_ror:4 row_mask:0xf bank_mask:0xf
  v_add_f32_dpp v116, v116, v116 row_ror:4 row_mask:0xf bank_mask:0xf
  v_add_f32_dpp v117, v117, v117 row_ror:4 row_mask:0xf bank_mask:0xf
  v_add_f32_dpp v118, v118, v118 row_ror:4 row_mask:0xf bank_mask:0xf
  v_add_f32_dpp v119, v119, v119 row_ror:4 row_mask:0xf bank_mask:0xf
  v_cvt_pk_bf16_f32 v120, v112, v113
  v_cvt_pk_bf16_f32 v121, v114, v115
  v_cvt_pk_bf16_f32 v122, v116, v117
  v_cvt_pk_bf16_f32 v123, v118, v119
  ds_write_b128 v104, v[120:123] offset:256
  buffer_load_dwordx4 a[64:67], v102, s[20:23], s53 offen offset:0 nt
  buffer_load_dwordx4 a[68:71], v102, s[20:23], s53 offen offset:1024 nt
  buffer_load_dwordx4 a[72:75], v102, s[20:23], s53 offen offset:2048 nt
  buffer_load_dwordx4 a[76:79], v102, s[20:23], s53 offen offset:3072 nt
  s_add_u32 s53, s53, s74
  buffer_load_dwordx4 a[80:83], v103, s[24:27], s53 offen offset:0 nt
  buffer_load_dwordx4 a[84:87], v103, s[24:27], s53 offen offset:1024 nt
  buffer_load_dwordx4 a[88:91], v103, s[24:27], s53 offen offset:2048 nt
  buffer_load_dwordx4 a[92:95], v103, s[24:27], s53 offen offset:3072 nt
  s_add_u32 s53, s53, 16384
  buffer_load_dwordx4 a[96:99], v102, s[20:23], s53 offen offset:0 nt
  buffer_load_dwordx4 a[100:103], v102, s[20:23], s53 offen offset:1024 nt
  buffer_load_dwordx4 a[104:107], v102, s[20:23], s53 offen offset:2048 nt
  buffer_load_dwordx4 a[108:111], v102, s[20:23], s53 offen offset:3072 nt
  s_add_u32 s53, s53, 16384
  buffer_load_dwordx4 a[112:115], v103, s[24:27], s53 offen offset:0 nt
  buffer_load_dwordx4 a[116:119], v103, s[24:27], s53 offen offset:1024 nt
  buffer_load_dwordx4 a[120:123], v103, s[24:27], s53 offen offset:2048 nt
  buffer_load_dwordx4 a[124:127], v103, s[24:27], s53 offen offset:3072 nt
  s_add_u32 s53, s53, 81920
  s_setprio 0
  s_waitcnt lgkmcnt(0)
  s_branch L_barA
L_w123:
  s_waitcnt vmcnt(7)
  buffer_load_dwordx4 a[0:3], v102, s[20:23], s53 offen offset:0 nt
  s_waitcnt vmcnt(7)
  buffer_load_dwordx4 a[4:7], v102, s[20:23], s53 offen offset:1024 nt
  s_waitcnt vmcnt(7)
  buffer_load_dwordx4 a[8:11], v102, s[20:23], s53 offen offset:2048 nt
  s_waitcnt vmcnt(7)
  buffer_load_dwordx4 a[12:15], v102, s[20:23], s53 offen offset:3072 nt
  s_add_u32 s53, s53, s74
  s_waitcnt vmcnt(7)
  buffer_load_dwordx4 a[16:19], v103, s[24:27], s53 offen offset:0 nt
  s_waitcnt vmcnt(7)
  buffer_load_dwordx4 a[20:23], v103, s[24:27], s53 offen offset:1024 nt
  s_waitcnt vmcnt(7)
  buffer_load_dwordx4 a[24:27], v103, s[24:27], s53 offen offset:2048 nt
  s_waitcnt vmcnt(7)
  buffer_load_dwordx4 a[28:31], v103, s[24:27], s53 offen offset:3072 nt
  s_add_u32 s53, s53, 16384
  s_waitcnt vmcnt(7)
  buffer_load_dwordx4 a[32:35], v102, s[20:23], s53 offen offset:0 nt
  s_waitcnt vmcnt(7)
  buffer_load_dwordx4 a[36:39], v102, s[20:23], s53 offen offset:1024 nt
  s_waitcnt vmcnt(7)
  buffer_load_dwordx4 a[40:43], v102, s[20:23], s53 offen offset:2048 nt
  s_waitcnt vmcnt(7)
  buffer_load_dwordx4 a[44:47], v102, s[20:23], s53 offen offset:3072 nt
  s_add_u32 s53, s53, 16384
  s_waitcnt vmcnt(7)
  buffer_load_dwordx4 a[48:51], v103, s[24:27], s53 offen offset:0 nt
  s_waitcnt vmcnt(7)
  buffer_load_dwordx4 a[52:55], v103, s[24:27], s53 offen offset:1024 nt
  s_waitcnt vmcnt(7)
  buffer_load_dwordx4 a[56:59], v103, s[24:27], s53 offen offset:2048 nt
  s_waitcnt vmcnt(7)
  buffer_load_dwordx4 a[60:63], v103, s[24:27], s53 offen offset:3072 nt
  s_add_u32 s53, s53, 81920
  s_waitcnt lgkmcnt(0)
  s_add_u32 s3, s3, 1
  s_and_b32 s40, s3, 0xff
  s_nop 0
  s_waitcnt vmcnt(7)
  buffer_load_dwordx4 a[64:67], v102, s[20:23], s53 offen offset:0 nt
  s_waitcnt vmcnt(7)
  buffer_load_dwordx4 a[68:71], v102, s[20:23], s53 offen offset:1024 nt
  s_waitcnt vmcnt(7)
  buffer_load_dwordx4 a[72:75], v102, s[20:23], s53 offen offset:2048 nt
  s_waitcnt vmcnt(7)
  buffer_load_dwordx4 a[76:79], v102, s[20:23], s53 offen offset:3072 nt
  s_add_u32 s53, s53, s74
  s_waitcnt vmcnt(7)
  buffer_load_dwordx4 a[80:83], v103, s[24:27], s53 offen offset:0 nt
  s_waitcnt vmcnt(7)
  buffer_load_dwordx4 a[84:87], v103, s[24:27], s53 offen offset:1024 nt
  s_waitcnt vmcnt(7)
  buffer_load_dwordx4 a[88:91], v103, s[24:27], s53 offen offset:2048 nt
  s_waitcnt vmcnt(7)
  buffer_load_dwordx4 a[92:95], v103, s[24:27], s53 offen offset:3072 nt
  s_add_u32 s53, s53, 16384
  s_waitcnt vmcnt(7)
  buffer_load_dwordx4 a[96:99], v102, s[20:23], s53 offen offset:0 nt
  s_waitcnt vmcnt(7)
  buffer_load_dwordx4 a[100:103], v102, s[20:23], s53 offen offset:1024 nt
  s_waitcnt vmcnt(7)
  buffer_load_dwordx4 a[104:107], v102, s[20:23], s53 offen offset:2048 nt
  s_waitcnt vmcnt(7)
  buffer_load_dwordx4 a[108:111], v102, s[20:23], s53 offen offset:3072 nt
  s_add_u32 s53, s53, 16384
  s_waitcnt vmcnt(7)
  buffer_load_dwordx4 a[112:115], v103, s[24:27], s53 offen offset:0 nt
  s_waitcnt vmcnt(7)
  buffer_load_dwordx4 a[116:119], v103, s[24:27], s53 offen offset:1024 nt
  s_waitcnt vmcnt(7)
  buffer_load_dwordx4 a[120:123], v103, s[24:27], s53 offen offset:2048 nt
  s_waitcnt vmcnt(7)
  buffer_load_dwordx4 a[124:127], v103, s[24:27], s53 offen offset:3072 nt
  s_add_u32 s53, s53, 81920
L_barA:
  s_barrier
  v_lshlrev_b32 v106, 4, v1
  ds_read_b128 v[120:123], v106 offset:256
  v_lshlrev_b32 v104, 2, v1
  v_lshl_add_u32 v104, v101, 12, v104
  v_mov_b32 v105, 0xff800000
  s_mov_b32 s71, 13
  s_waitcnt lgkmcnt(0)
  v_cndmask_b32 v24, 0, v120, s[60:61]
  v_cndmask_b32 v25, 0, v121, s[60:61]
  v_cndmask_b32 v26, 0, v122, s[60:61]
  v_cndmask_b32 v27, 0, v123, s[60:61]
  v_cndmask_b32 v28, 0, v120, s[62:63]
  v_cndmask_b32 v29, 0, v121, s[62:63]
  v_cndmask_b32 v30, 0, v122, s[62:63]
  v_cndmask_b32 v31, 0, v123, s[62:63]
  v_cndmask_b32 v32, 0, v120, s[64:65]
  v_cndmask_b32 v33, 0, v121, s[64:65]
  v_cndmask_b32 v34, 0, v122, s[64:65]
  v_cndmask_b32 v35, 0, v123, s[64:65]
  v_cndmask_b32 v36, 0, v120, s[66:67]
  v_cndmask_b32 v37, 0, v121, s[66:67]
  v_cndmask_b32 v38, 0, v122, s[66:67]
  v_cndmask_b32 v39, 0, v123, s[66:67]
  s_mov_b32 s62, 0x22222222
  s_mov_b32 s63, 0x22222222
  s_mov_b32 s64, 0x44444444
  s_mov_b32 s65, 0x44444444
  s_mov_b32 s66, 0x88888888
  s_mov_b32 s67, 0x88888888
  v_mfma_f32_16x16x32_bf16 v[16:19], a[0:3], v[24:27], 0
  buffer_load_dwordx4 a[0:3], v102, s[20:23], s53 offen offset:0 nt
  v_mfma_f32_16x16x32_bf16 v[16:19], a[4:7], v[28:31], v[16:19]
  buffer_load_dwordx4 a[4:7], v102, s[20:23], s53 offen offset:1024 nt
  v_mfma_f32_16x16x32_bf16 v[16:19], a[8:11], v[32:35], v[16:19]
  buffer_load_dwordx4 a[8:11], v102, s[20:23], s53 offen offset:2048 nt
  v_mfma_f32_16x16x32_bf16 v[16:19], a[12:15], v[36:39], v[16:19]
  buffer_load_dwordx4 a[12:15], v102, s[20:23], s53 offen offset:3072 nt
  s_add_u32 s53, s53, s74
  s_nop 7
  v_mul_f32_dpp v63, v16, v4 quad_perm:[0,0,0,0] row_mask:0xf bank_mask:0xf
  v_fmac_f32_dpp v63, v17, v4 quad_perm:[1,1,1,1] row_mask:0xf bank_mask:0xf
  v_fmac_f32_dpp v63, v18, v4 quad_perm:[2,2,2,2] row_mask:0xf bank_mask:0xf
  v_fmac_f32_dpp v63, v19, v4 quad_perm:[3,3,3,3] row_mask:0xf bank_mask:0xf
  v_mfma_f32_16x16x32_bf16 v[16:19], a[16:19], v[24:27], 0
  buffer_load_dwordx4 a[16:19], v103, s[24:27], s53 offen offset:0 nt
  v_mfma_f32_16x16x32_bf16 v[16:19], a[20:23], v[28:31], v[16:19]
  v_mfma_f32_16x16x32_bf16 v[16:19], a[24:27], v[32:35], v[16:19]
  v_mfma_f32_16x16x32_bf16 v[16:19], a[28:31], v[36:39], v[16:19]
  s_nop 7
  v_mul_f32_dpp v5, v16, v4 quad_perm:[0,0,0,0] row_mask:0xf bank_mask:0xf
  v_fmac_f32_dpp v5, v17, v4 quad_perm:[1,1,1,1] row_mask:0xf bank_mask:0xf
  v_fmac_f32_dpp v5, v18, v4 quad_perm:[2,2,2,2] row_mask:0xf bank_mask:0xf
  v_fmac_f32_dpp v5, v19, v4 quad_perm:[3,3,3,3] row_mask:0xf bank_mask:0xf
  v_cndmask_b32 v63, v63, v5, s[62:63]
  v_mfma_f32_16x16x32_bf16 v[16:19], a[32:35], v[24:27], 0
  v_mfma_f32_16x16x32_bf16 v[16:19], a[36:39], v[28:31], v[16:19]
  v_mfma_f32_16x16x32_bf16 v[16:19], a[40:43], v[32:35], v[16:19]
  v_mfma_f32_16x16x32_bf16 v[16:19], a[44:47], v[36:39], v[16:19]
  s_nop 7
  v_mul_f32_dpp v5, v16, v4 quad_perm:[0,0,0,0] row_mask:0xf bank_mask:0xf
  v_fmac_f32_dpp v5, v17, v4 quad_perm:[1,1,1,1] row_mask:0xf bank_mask:0xf
  v_fmac_f32_dpp v5, v18, v4 quad_perm:[2,2,2,2] row_mask:0xf bank_mask:0xf
  v_fmac_f32_dpp v5, v19, v4 quad_perm:[3,3,3,3] row_mask:0xf bank_mask:0xf
  v_cndmask_b32 v63, v63, v5, s[64:65]
  v_mfma_f32_16x16x32_bf16 v[16:19], a[48:51], v[24:27], 0
  v_mfma_f32_16x16x32_bf16 v[16:19], a[52:55], v[28:31], v[16:19]
  v_mfma_f32_16x16x32_bf16 v[16:19], a[56:59], v[32:35], v[16:19]
  v_mfma_f32_16x16x32_bf16 v[16:19], a[60:63], v[36:39], v[16:19]
  s_nop 7
  v_mul_f32_dpp v5, v16, v4 quad_perm:[0,0,0,0] row_mask:0xf bank_mask:0xf
  v_fmac_f32_dpp v5, v17, v4 quad_perm:[1,1,1,1] row_mask:0xf bank_mask:0xf
  v_fmac_f32_dpp v5, v18, v4 quad_perm:[2,2,2,2] row_mask:0xf bank_mask:0xf
  v_fmac_f32_dpp v5, v19, v4 quad_perm:[3,3,3,3] row_mask:0xf bank_mask:0xf
  v_cndmask_b32 v63, v63, v5, s[66:67]
  ds_write_b32 v104, v63 offset:12288
  v_max_f32 v105, v105, v63
  v_add_u32 v104, 0x100, v104
  s_waitcnt vmcnt(5)
  v_mfma_f32_16x16x32_bf16 v[16:19], a[64:67], v[24:27], 0
  v_mfma_f32_16x16x32_bf16 v[16:19], a[68:71], v[28:31], v[16:19]
  v_mfma_f32_16x16x32_bf16 v[16:19], a[72:75], v[32:35], v[16:19]
  v_mfma_f32_16x16x32_bf16 v[16:19], a[76:79], v[36:39], v[16:19]
  s_nop 7
  v_mul_f32_dpp v63, v16, v4 quad_perm:[0,0,0,0] row_mask:0xf bank_mask:0xf
  v_fmac_f32_dpp v63, v17, v4 quad_perm:[1,1,1,1] row_mask:0xf bank_mask:0xf
  v_fmac_f32_dpp v63, v18, v4 quad_perm:[2,2,2,2] row_mask:0xf bank_mask:0xf
  v_fmac_f32_dpp v63, v19, v4 quad_perm:[3,3,3,3] row_mask:0xf bank_mask:0xf
  v_mfma_f32_16x16x32_bf16 v[16:19], a[80:83], v[24:27], 0
  v_mfma_f32_16x16x32_bf16 v[16:19], a[84:87], v[28:31], v[16:19]
  v_mfma_f32_16x16x32_bf16 v[16:19], a[88:91], v[32:35], v[16:19]
  v_mfma_f32_16x16x32_bf16 v[16:19], a[92:95], v[36:39], v[16:19]
  s_nop 7
  v_mul_f32_dpp v5, v16, v4 quad_perm:[0,0,0,0] row_mask:0xf bank_mask:0xf
  v_fmac_f32_dpp v5, v17, v4 quad_perm:[1,1,1,1] row_mask:0xf bank_mask:0xf
  v_fmac_f32_dpp v5, v18, v4 quad_perm:[2,2,2,2] row_mask:0xf bank_mask:0xf
  v_fmac_f32_dpp v5, v19, v4 quad_perm:[3,3,3,3] row_mask:0xf bank_mask:0xf
  v_cndmask_b32 v63, v63, v5, s[62:63]
  v_mfma_f32_16x16x32_bf16 v[16:19], a[96:99], v[24:27], 0
  v_mfma_f32_16x16x32_bf16 v[16:19], a[100:103], v[28:31], v[16:19]
  v_mfma_f32_16x16x32_bf16 v[16:19], a[104:107], v[32:35], v[16:19]
  v_mfma_f32_16x16x32_bf16 v[16:19], a[108:111], v[36:39], v[16:19]
  s_nop 7
  v_mul_f32_dpp v5, v16, v4 quad_perm:[0,0,0,0] row_mask:0xf bank_mask:0xf
  v_fmac_f32_dpp v5, v17, v4 quad_perm:[1,1,1,1] row_mask:0xf bank_mask:0xf
  v_fmac_f32_dpp v5, v18, v4 quad_perm:[2,2,2,2] row_mask:0xf bank_mask:0xf
  v_fmac_f32_dpp v5, v19, v4 quad_perm:[3,3,3,3] row_mask:0xf bank_mask:0xf
  v_cndmask_b32 v63, v63, v5, s[64:65]
  v_mfma_f32_16x16x32_bf16 v[16:19], a[112:115], v[24:27], 0
  v_mfma_f32_16x16x32_bf16 v[16:19], a[116:119], v[28:31], v[16:19]
  v_mfma_f32_16x16x32_bf16 v[16:19], a[120:123], v[32:35], v[16:19]
  v_mfma_f32_16x16x32_bf16 v[16:19], a[124:127], v[36:39], v[16:19]
  s_nop 7
  v_mul_f32_dpp v5, v16, v4 quad_perm:[0,0,0,0] row_mask:0xf bank_mask:0xf
  v_fmac_f32_dpp v5, v17, v4 quad_perm:[1,1,1,1] row_mask:0xf bank_mask:0xf
  v_fmac_f32_dpp v5, v18, v4 quad_perm:[2,2,2,2] row_mask:0xf bank_mask:0xf
  v_fmac_f32_dpp v5, v19, v4 quad_perm:[3,3,3,3] row_mask:0xf bank_mask:0xf
  v_cndmask_b32 v63, v63, v5, s[66:67]
  ds_write_b32 v104, v63 offset:12288
  v_max_f32 v105, v105, v63
  v_add_u32 v104, 0x100, v104
L_kloop:
  s_barrier
  s_waitcnt vmcnt(4)
  buffer_load_dwordx4 a[20:23], v103, s[24:27], s53 offen offset:1024 nt
  v_mfma_f32_16x16x32_bf16 v[16:19], a[0:3], v[24:27], 0
  s_waitcnt vmcnt(4)
  buffer_load_dwordx4 a[24:27], v103, s[24:27], s53 offen offset:2048 nt
  v_mfma_f32_16x16x32_bf16 v[16:19], a[4:7], v[28:31], v[16:19]
  s_waitcnt vmcnt(4)
  buffer_load_dwordx4 a[28:31], v103, s[24:27], s53 offen offset:3072 nt
  s_add_u32 s53, s53, 16384
  v_mfma_f32_16x16x32_bf16 v[16:19], a[8:11], v[32:35], v[16:19]
  s_waitcnt vmcnt(4)
  buffer_load_dwordx4 a[32:35], v102, s[20:23], s53 offen offset:0 nt
  v_mfma_f32_16x16x32_bf16 v[16:19], a[12:15], v[36:39], v[16:19]
  s_nop 7
  v_mul_f32_dpp v63, v16, v4 quad_perm:[0,0,0,0] row_mask:0xf bank_mask:0xf
  v_fmac_f32_dpp v63, v17, v4 quad_perm:[1,1,1,1] row_mask:0xf bank_mask:0xf
  v_fmac_f32_dpp v63, v18, v4 quad_perm:[2,2,2,2] row_mask:0xf bank_mask:0xf
  v_fmac_f32_dpp v63, v19, v4 quad_perm:[3,3,3,3] row_mask:0xf bank_mask:0xf
  s_waitcnt vmcnt(4)
  buffer_load_dwordx4 a[36:39], v102, s[20:23], s53 offen offset:1024 nt
  v_mfma_f32_16x16x32_bf16 v[16:19], a[16:19], v[24:27], 0
  s_waitcnt vmcnt(4)
  buffer_load_dwordx4 a[40:43], v102, s[20:23], s53 offen offset:2048 nt
  v_mfma_f32_16x16x32_bf16 v[16:19], a[20:23], v[28:31], v[16:19]
  s_waitcnt vmcnt(4)
  buffer_load_dwordx4 a[44:47], v102, s[20:23], s53 offen offset:3072 nt
  s_add_u32 s53, s53, 16384
  v_mfma_f32_16x16x32_bf16 v[16:19], a[24:27], v[32:35], v[16:19]
  s_waitcnt vmcnt(4)
  buffer_load_dwordx4 a[48:51], v103, s[24:27], s53 offen offset:0 nt
  v_mfma_f32_16x16x32_bf16 v[16:19], a[28:31], v[36:39], v[16:19]
  s_nop 7
  v_mul_f32_dpp v5, v16, v4 quad_perm:[0,0,0,0] row_mask:0xf bank_mask:0xf
  v_fmac_f32_dpp v5, v17, v4 quad_perm:[1,1,1,1] row_mask:0xf bank_mask:0xf
  v_fmac_f32_dpp v5, v18, v4 quad_perm:[2,2,2,2] row_mask:0xf bank_mask:0xf
  v_fmac_f32_dpp v5, v19, v4 quad_perm:[3,3,3,3] row_mask:0xf bank_mask:0xf
  v_cndmask_b32 v63, v63, v5, s[62:63]
  s_waitcnt vmcnt(4)
  buffer_load_dwordx4 a[52:55], v103, s[24:27], s53 offen offset:1024 nt
  v_mfma_f32_16x16x32_bf16 v[16:19], a[32:35], v[24:27], 0
  s_waitcnt vmcnt(4)
  buffer_load_dwordx4 a[56:59], v103, s[24:27], s53 offen offset:2048 nt
  v_mfma_f32_16x16x32_bf16 v[16:19], a[36:39], v[28:31], v[16:19]
  s_waitcnt vmcnt(4)
  buffer_load_dwordx4 a[60:63], v103, s[24:27], s53 offen offset:3072 nt
  s_add_u32 s53, s53, 81920
  v_mfma_f32_16x16x32_bf16 v[16:19], a[40:43], v[32:35], v[16:19]
  s_sub_u32 s71, s71, 1
  s_cmp_lg_u32 s71, 0
  s_cbranch_scc1 L_kgo
  s_mov_b64 s[20:21], s[8:9]
  s_mov_b64 s[24:25], s[8:9]
  v_mov_b32 v102, v3
  v_mov_b32 v103, v3
  s_mov_b32 s53, s75
L_kgo:
  s_waitcnt vmcnt(4)
  buffer_load_dwordx4 a[0:3], v102, s[20:23], s53 offen offset:0 nt
  v_mfma_f32_16x16x32_bf16 v[16:19], a[44:47], v[36:39], v[16:19]
  s_nop 7
  v_mul_f32_dpp v5, v16, v4 quad_perm:[0,0,0,0] row_mask:0xf bank_mask:0xf
  v_fmac_f32_dpp v5, v17, v4 quad_perm:[1,1,1,1] row_mask:0xf bank_mask:0xf
  v_fmac_f32_dpp v5, v18, v4 quad_perm:[2,2,2,2] row_mask:0xf bank_mask:0xf
  v_fmac_f32_dpp v5, v19, v4 quad_perm:[3,3,3,3] row_mask:0xf bank_mask:0xf
  v_cndmask_b32 v63, v63, v5, s[64:65]
  s_waitcnt vmcnt(4)
  buffer_load_dwordx4 a[4:7], v102, s[20:23], s53 offen offset:1024 nt
  v_mfma_f32_16x16x32_bf16 v[16:19], a[48:51], v[24:27], 0
  s_waitcnt vmcnt(4)
  buffer_load_dwordx4 a[8:11], v102, s[20:23], s53 offen offset:2048 nt
  v_mfma_f32_16x16x32_bf16 v[16:19], a[52:55], v[28:31], v[16:19]
  s_waitcnt vmcnt(4)
  buffer_load_dwordx4 a[12:15], v102, s[20:23], s53 offen offset:3072 nt
  s_add_u32 s53, s53, s74
  v_mfma_f32_16x16x32_bf16 v[16:19], a[56:59], v[32:35], v[16:19]
  s_waitcnt vmcnt(4)
  buffer_load_dwordx4 a[16:19], v103, s[24:27], s53 offen offset:0 nt
  v_mfma_f32_16x16x32_bf16 v[16:19], a[60:63], v[36:39], v[16:19]
  s_nop 7
  v_mul_f32_dpp v5, v16, v4 quad_perm:[0,0,0,0] row_mask:0xf bank_mask:0xf
  v_fmac_f32_dpp v5, v17, v4 quad_perm:[1,1,1,1] row_mask:0xf bank_mask:0xf
  v_fmac_f32_dpp v5, v18, v4 quad_perm:[2,2,2,2] row_mask:0xf bank_mask:0xf
  v_fmac_f32_dpp v5, v19, v4 quad_perm:[3,3,3,3] row_mask:0xf bank_mask:0xf
  v_cndmask_b32 v63, v63, v5, s[66:67]
  ds_write_b32 v104, v63 offset:12288
  v_max_f32 v105, v105, v63
  v_add_u32 v104, 0x100, v104
  s_cmp_lg_u32 s71, 0
  s_cbranch_scc1 L_kloop
  v_max_f32_dpp v105, v105, v105 quad_perm:[1,0,3,2] row_mask:0xf bank_mask:0xf
  v_add_u32 v104, 0xfffff100, v104
  s_mov_b32 s71, 15
  s_nop 0
  v_max_f32_dpp v105, v105, v105 quad_perm:[2,3,0,1] row_mask:0xf bank_mask:0xf
  s_nop 1
  v_max_f32_dpp v105, v105, v105 row_ror:4 row_mask:0xf bank_mask:0xf
  s_nop 1
  v_max_f32_dpp v105, v105, v105 row_ror:8 row_mask:0xf bank_mask:0xf
  v_mov_b32 v58, v105
  s_nop 1
  v_permlane16_swap_b32 v105, v58
  s_nop 1
  v_max_f32 v105, v105, v58
  v_mov_b32 v58, v105
  s_nop 1
  v_permlane32_swap_b32 v105, v58
  s_nop 1
  v_max_f32 v105, v105, v58
  v_mul_f32 v12, s68, v105
  v_mul_f32 v105, s69, v12
  ds_read_b32 v5, v104 offset:12288
  s_waitcnt lgkmcnt(0)
  v_sub_f32 v5, v5, v105
  v_exp_f32 v6, v5
  s_nop 0
  v_cvt_pk_bf16_f32 v7, v6, v6
  v_add_f32 v56, v56, v6
  s_nop 0
  v_and_b32_dpp v40, v7, v8 row_newbcast:0 row_mask:0xf bank_mask:0xf
  v_and_b32_dpp v41, v7, v9 row_newbcast:0 row_mask:0xf bank_mask:0xf
  v_and_b32_dpp v42, v7, v10 row_newbcast:0 row_mask:0xf bank_mask:0xf
  v_and_b32_dpp v43, v7, v11 row_newbcast:0 row_mask:0xf bank_mask:0xf
L_vloop:
  ds_read_b32 v5, v104 offset:12544
  v_add_u32 v104, 0x100, v104
  s_sub_u32 s71, s71, 1
  s_barrier
  s_waitcnt vmcnt(4)
  buffer_load_dwordx4 a[20:23], v103, s[24:27], s53 offen offset:1024 nt
  v_mfma_f32_16x16x32_bf16 v[20:23], v[40:43], a[0:3], v[20:23]
  v_and_b32_dpp v44, v7, v8 row_newbcast:4 row_mask:0xf bank_mask:0xf
  v_and_b32_dpp v45, v7, v9 row_newbcast:4 row_mask:0xf bank_mask:0xf
  v_and_b32_dpp v46, v7, v10 row_newbcast:4 row_mask:0xf bank_mask:0xf
  v_and_b32_dpp v47, v7, v11 row_newbcast:4 row_mask:0xf bank_mask:0xf
  s_waitcnt vmcnt(4)
  buffer_load_dwordx4 a[24:27], v103, s[24:27], s53 offen offset:2048 nt
  v_mfma_f32_16x16x32_bf16 v[20:23], v[44:47], a[4:7], v[20:23]
  v_and_b32_dpp v48, v7, v8 row_newbcast:8 row_mask:0xf bank_mask:0xf
  v_and_b32_dpp v49, v7, v9 row_newbcast:8 row_mask:0xf bank_mask:0xf
  v_and_b32_dpp v50, v7, v10 row_newbcast:8 row_mask:0xf bank_mask:0xf
  v_and_b32_dpp v51, v7, v11 row_newbcast:8 row_mask:0xf bank_mask:0xf
  s_waitcnt lgkmcnt(0)
  v_sub_f32 v5, v5, v105
  v_exp_f32 v6, v5
  s_nop 0
  v_cvt_pk_bf16_f32 v108, v6, v6
  s_waitcnt vmcnt(4)
  buffer_load_dwordx4 a[28:31], v103, s[24:27], s53 offen offset:3072 nt
  s_add_u32 s53, s53, 16384
  v_mfma_f32_16x16x32_bf16 v[20:23], v[48:51], a[8:11], v[20:23]
  v_and_b32_dpp v52, v7, v8 row_newbcast:12 row_mask:0xf bank_mask:0xf
  v_and_b32_dpp v53, v7, v9 row_newbcast:12 row_mask:0xf bank_mask:0xf
  v_and_b32_dpp v54, v7, v10 row_newbcast:12 row_mask:0xf bank_mask:0xf
  v_and_b32_dpp v55, v7, v11 row_newbcast:12 row_mask:0xf bank_mask:0xf
  s_waitcnt vmcnt(4)
  buffer_load_dwordx4 a[32:35], v102, s[20:23], s53 offen offset:0 nt
  v_mfma_f32_16x16x32_bf16 v[20:23], v[52:55], a[12:15], v[20:23]
  v_and_b32_dpp v40, v7, v8 row_newbcast:1 row_mask:0xf bank_mask:0xf
  v_and_b32_dpp v41, v7, v9 row_newbcast:1 row_mask:0xf bank_mask:0xf
  v_and_b32_dpp v42, v7, v10 row_newbcast:1 row_mask:0xf bank_mask:0xf
  v_and_b32_dpp v43, v7, v11 row_newbcast:1 row_mask:0xf bank_mask:0xf
  s_waitcnt vmcnt(4)
  buffer_load_dwordx4 a[36:39], v102, s[20:23], s53 offen offset:1024 nt
  v_mfma_f32_16x16x32_bf16 v[20:23], v[40:43], a[16:19], v[20:23]
  v_and_b32_dpp v44, v7, v8 row_newbcast:5 row_mask:0xf bank_mask:0xf
  v_and_b32_dpp v45, v7, v9 row_newbcast:5 row_mask:0xf bank_mask:0xf
  v_and_b32_dpp v46, v7, v10 row_newbcast:5 row_mask:0xf bank_mask:0xf
  v_and_b32_dpp v47, v7, v11 row_newbcast:5 row_mask:0xf bank_mask:0xf
  s_or_b32 s57, s71, s50
  s_cbranch_scc1 L_vnr
  s_mov_b32 s54, 1
  s_atomic_add s54, s[18:19], s55 glc
L_vnr:
  s_waitcnt vmcnt(4)
  buffer_load_dwordx4 a[40:43], v102, s[20:23], s53 offen offset:2048 nt
  v_mfma_f32_16x16x32_bf16 v[20:23], v[44:47], a[20:23], v[20:23]
  v_and_b32_dpp v48, v7, v8 row_newbcast:9 row_mask:0xf bank_mask:0xf
  v_and_b32_dpp v49, v7, v9 row_newbcast:9 row_mask:0xf bank_mask:0xf
  v_and_b32_dpp v50, v7, v10 row_newbcast:9 row_mask:0xf bank_mask:0xf
  v_and_b32_dpp v51, v7, v11 row_newbcast:9 row_mask:0xf bank_mask:0xf
  s_waitcnt vmcnt(4)
  buffer_load_dwordx4 a[44:47], v102, s[20:23], s53 offen offset:3072 nt
  s_add_u32 s53, s53, 16384
  v_mfma_f32_16x16x32_bf16 v[20:23], v[48:51], a[24:27], v[20:23]
  v_and_b32_dpp v52, v7, v8 row_newbcast:13 row_mask:0xf bank_mask:0xf
  v_and_b32_dpp v53, v7, v9 row_newbcast:13 row_mask:0xf bank_mask:0xf
  v_and_b32_dpp v54, v7, v10 row_newbcast:13 row_mask:0xf bank_mask:0xf
  v_and_b32_dpp v55, v7, v11 row_newbcast:13 row_mask:0xf bank_mask:0xf
  s_waitcnt vmcnt(4)
  buffer_load_dwordx4 a[48:51], v103, s[24:27], s53 offen offset:0 nt
  v_mfma_f32_16x16x32_bf16 v[20:23], v[52:55], a[28:31], v[20:23]
  v_and_b32_dpp v40, v7, v8 row_newbcast:2 row_mask:0xf bank_mask:0xf
  v_and_b32_dpp v41, v7, v9 row_newbcast:2 row_mask:0xf bank_mask:0xf
  v_and_b32_dpp v42, v7, v10 row_newbcast:2 row_mask:0xf bank_mask:0xf
  v_and_b32_dpp v43, v7, v11 row_newbcast:2 row_mask:0xf bank_mask:0xf
  s_cmp_lg_u32 s57, 0
  s_cbranch_scc1 L_vnp
  s_waitcnt lgkmcnt(0)
  s_lshr_b32 s47, s54, 3
  s_mov_b32 s57, s47
  s_mov_b32 s58, 1
  s_min_u32 s59, s47, 1
  s_addc_u32 s58, s58, 0
  s_add_u32 s57, s57, s59
  s_and_b32 s59, s54, 6
  s_lshl_b32 s59, s59, 6
  s_bitcmp1_b32 s54, 0
  s_cselect_b32 s47, 4, 0
  s_add_u32 s59, s59, s47
  s_add_u32 s59, s59, 120
  s_add_u32 s59, s59, s57
  s_lshl_b32 s59, s59, 14
  s_cmp_ge_u32 s57, 4
  s_cselect_b32 s57, 8388608, s59
  s_cselect_b32 s58, 0xff, s58
  s_or_b32 s57, s57, s58
  v_mov_b32 v60, s57
  ds_write_b32 v61, v60
  s_waitcnt lgkmcnt(0)
L_vnp:
  s_barrier
  s_waitcnt vmcnt(4)
  buffer_load_dwordx4 a[52:55], v103, s[24:27], s53 offen offset:1024 nt
  v_mfma_f32_16x16x32_bf16 v[20:23], v[40:43], a[32:35], v[20:23]
  v_and_b32_dpp v44, v7, v8 row_newbcast:6 row_mask:0xf bank_mask:0xf
  v_and_b32_dpp v45, v7, v9 row_newbcast:6 row_mask:0xf bank_mask:0xf
  v_and_b32_dpp v46, v7, v10 row_newbcast:6 row_mask:0xf bank_mask:0xf
  v_and_b32_dpp v47, v7, v11 row_newbcast:6 row_mask:0xf bank_mask:0xf
  s_waitcnt vmcnt(4)
  buffer_load_dwordx4 a[56:59], v103, s[24:27], s53 offen offset:2048 nt
  v_mfma_f32_16x16x32_bf16 v[20:23], v[44:47], a[36:39], v[20:23]
  v_and_b32_dpp v48, v7, v8 row_newbcast:10 row_mask:0xf bank_mask:0xf
  v_and_b32_dpp v49, v7, v9 row_newbcast:10 row_mask:0xf bank_mask:0xf
  v_and_b32_dpp v50, v7, v10 row_newbcast:10 row_mask:0xf bank_mask:0xf
  v_and_b32_dpp v51, v7, v11 row_newbcast:10 row_mask:0xf bank_mask:0xf
  s_waitcnt vmcnt(4)
  buffer_load_dwordx4 a[60:63], v103, s[24:27], s53 offen offset:3072 nt
  s_add_u32 s53, s53, 81920
  v_mfma_f32_16x16x32_bf16 v[20:23], v[48:51], a[40:43], v[20:23]
  v_and_b32_dpp v52, v7, v8 row_newbcast:14 row_mask:0xf bank_mask:0xf
  v_and_b32_dpp v53, v7, v9 row_newbcast:14 row_mask:0xf bank_mask:0xf
  v_and_b32_dpp v54, v7, v10 row_newbcast:14 row_mask:0xf bank_mask:0xf
  v_and_b32_dpp v55, v7, v11 row_newbcast:14 row_mask:0xf bank_mask:0xf
  s_cmp_lg_u32 s71, 0
  s_cbranch_scc1 L_vgo
  ds_read_b32 v60, v61
  s_waitcnt lgkmcnt(0)
  v_readfirstlane_b32 s53, v60
  v_xor_b32 v61, 4, v61
  s_and_b32 s56, s53, 0xff
  s_andn2_b32 s53, s53, 0xff
  s_mov_b64 s[20:21], s[6:7]
  v_mov_b32 v102, v2
  s_mov_b32 s74, 0
  s_mov_b32 s51, s53
  s_cmp_ge_u32 s53, 8388608
  s_cselect_b32 s22, 0, 8388608
  s_cselect_b32 s26, 0, 8388608
  s_sub_u32 s56, s56, 1
  s_or_b32 s57, s56, s50
  s_cbranch_scc1 L_vgo
  s_mov_b32 s54, 1
  s_atomic_add s54, s[18:19], s55 glc
L_vgo:
  s_waitcnt vmcnt(4)
  buffer_load_dwordx4 a[0:3], v102, s[20:23], s53 offen offset:0 nt
  v_mfma_f32_16x16x32_bf16 v[20:23], v[52:55], a[44:47], v[20:23]
  v_and_b32_dpp v40, v7, v8 row_newbcast:3 row_mask:0xf bank_mask:0xf
  v_and_b32_dpp v41, v7, v9 row_newbcast:3 row_mask:0xf bank_mask:0xf
  v_and_b32_dpp v42, v7, v10 row_newbcast:3 row_mask:0xf bank_mask:0xf
  v_and_b32_dpp v43, v7, v11 row_newbcast:3 row_mask:0xf bank_mask:0xf
  s_waitcnt vmcnt(4)
  buffer_load_dwordx4 a[4:7], v102, s[20:23], s53 offen offset:1024 nt
  v_mfma_f32_16x16x32_bf16 v[20:23], v[40:43], a[48:51], v[20:23]
  v_and_b32_dpp v44, v7, v8 row_newbcast:7 row_mask:0xf bank_mask:0xf
  v_and_b32_dpp v45, v7, v9 row_newbcast:7 row_mask:0xf bank_mask:0xf
  v_and_b32_dpp v46, v7, v10 row_newbcast:7 row_mask:0xf bank_mask:0xf
  v_and_b32_dpp v47, v7, v11 row_newbcast:7 row_mask:0xf bank_mask:0xf
  s_waitcnt vmcnt(4)
  buffer_load_dwordx4 a[8:11], v102, s[20:23], s53 offen offset:2048 nt
  v_mfma_f32_16x16x32_bf16 v[20:23], v[44:47], a[52:55], v[20:23]
  v_and_b32_dpp v48, v7, v8 row_newbcast:11 row_mask:0xf bank_mask:0xf
  v_and_b32_dpp v49, v7, v9 row_newbcast:11 row_mask:0xf bank_mask:0xf
  v_and_b32_dpp v50, v7, v10 row_newbcast:11 row_mask:0xf bank_mask:0xf
  v_and_b32_dpp v51, v7, v11 row_newbcast:11 row_mask:0xf bank_mask:0xf
  s_waitcnt vmcnt(4)
  buffer_load_dwordx4 a[12:15], v102, s[20:23], s53 offen offset:3072 nt
  s_add_u32 s53, s53, s74
  v_mfma_f32_16x16x32_bf16 v[20:23], v[48:51], a[56:59], v[20:23]
  v_and_b32_dpp v52, v7, v8 row_newbcast:15 row_mask:0xf bank_mask:0xf
  v_and_b32_dpp v53, v7, v9 row_newbcast:15 row_mask:0xf bank_mask:0xf
  v_and_b32_dpp v54, v7, v10 row_newbcast:15 row_mask:0xf bank_mask:0xf
  v_and_b32_dpp v55, v7, v11 row_newbcast:15 row_mask:0xf bank_mask:0xf
  s_waitcnt vmcnt(4)
  buffer_load_dwordx4 a[16:19], v103, s[24:27], s53 offen offset:0 nt
  v_mfma_f32_16x16x32_bf16 v[20:23], v[52:55], a[60:63], v[20:23]
  v_and_b32_dpp v40, v108, v8 row_newbcast:0 row_mask:0xf bank_mask:0xf
  v_and_b32_dpp v41, v108, v9 row_newbcast:0 row_mask:0xf bank_mask:0xf
  v_and_b32_dpp v42, v108, v10 row_newbcast:0 row_mask:0xf bank_mask:0xf
  v_and_b32_dpp v43, v108, v11 row_newbcast:0 row_mask:0xf bank_mask:0xf
  s_cmp_lg_u32 s71, 0
  s_cbranch_scc0 L_vdone
  v_mov_b32 v7, v108
  v_add_f32 v56, v56, v6
  s_branch L_vloop
L_vdone:
  v_add_f32_dpp v56, v56, v56 quad_perm:[1,0,3,2] row_mask:0xf bank_mask:0xf
  buffer_load_dwordx4 a[20:23], v103, s[24:27], s51 offen offset:1024 nt
  buffer_load_dwordx4 a[24:27], v103, s[24:27], s51 offen offset:2048 nt
  s_add_u32 s53, s51, 16384
  s_nop 0
  v_add_f32_dpp v56, v56, v56 quad_perm:[2,3,0,1] row_mask:0xf bank_mask:0xf
  s_cmp_ge_u32 s51, 8388608
  s_cbranch_scc1 L_nopool
  s_cmp_lg_u32 s57, 0
  s_cbranch_scc1 L_loop
  s_waitcnt lgkmcnt(0)
  s_lshr_b32 s47, s54, 3
  s_mov_b32 s57, s47
  s_mov_b32 s58, 1
  s_min_u32 s59, s47, 1
  s_addc_u32 s58, s58, 0
  s_add_u32 s57, s57, s59
  s_and_b32 s59, s54, 6
  s_lshl_b32 s59, s59, 6
  s_bitcmp1_b32 s54, 0
  s_cselect_b32 s47, 4, 0
  s_add_u32 s59, s59, s47
  s_add_u32 s59, s59, 120
  s_add_u32 s59, s59, s57
  s_lshl_b32 s59, s59, 14
  s_cmp_ge_u32 s57, 4
  s_cselect_b32 s57, 8388608, s59
  s_cselect_b32 s58, 0xff, s58
  s_or_b32 s57, s57, s58
  v_mov_b32 v60, s57
  ds_write_b32 v61, v60
  s_waitcnt lgkmcnt(0)
L_loop:
  s_barrier
  s_cmp_lg_u32 s56, 0
  s_cbranch_scc1 L_have0
  ds_read_b32 v60, v61
  s_waitcnt lgkmcnt(0)
  v_readfirstlane_b32 s53, v60
  v_xor_b32 v61, 4, v61
  s_and_b32 s56, s53, 0xff
  s_andn2_b32 s53, s53, 0xff
L_have0:
  s_cmp_ge_u32 s53, 8388608
  s_cbranch_scc1 L_final
  s_sub_u32 s56, s56, 1
  s_or_b32 s57, s56, s50
  s_waitcnt vmcnt(6)
  buffer_load_dwordx4 a[28:31], v103, s[24:27], s51 offen offset:3072 nt
  v_mfma_f32_16x16x32_bf16 v[16:19], a[0:3], v[24:27], v[12:15]
  s_waitcnt vmcnt(6)
  buffer_load_dwordx4 a[0:3], v102, s[20:23], s53 offen offset:0 nt
  v_mfma_f32_16x16x32_bf16 v[16:19], a[4:7], v[28:31], v[16:19]
  s_waitcnt vmcnt(6)
  buffer_load_dwordx4 a[4:7], v102, s[20:23], s53 offen offset:1024 nt
  v_mfma_f32_16x16x32_bf16 v[16:19], a[8:11], v[32:35], v[16:19]
  s_waitcnt vmcnt(6)
  buffer_load_dwordx4 a[8:11], v102, s[20:23], s53 offen offset:2048 nt
  v_mfma_f32_16x16x32_bf16 v[16:19], a[12:15], v[36:39], v[16:19]
  s_nop 7
  v_mul_f32_dpp v5, v16, v4 quad_perm:[0,0,0,0] row_mask:0xf bank_mask:0xf
  v_fmac_f32_dpp v5, v17, v4 quad_perm:[1,1,1,1] row_mask:0xf bank_mask:0xf
  v_fmac_f32_dpp v5, v18, v4 quad_perm:[2,2,2,2] row_mask:0xf bank_mask:0xf
  v_fmac_f32_dpp v5, v19, v4 quad_perm:[3,3,3,3] row_mask:0xf bank_mask:0xf
  v_cmp_lt_f32 vcc, 0, v5
  s_cbranch_vccz L_nors0
  v_max_f32_dpp v57, v5, v5 row_ror:4 row_mask:0xf bank_mask:0xf
  s_nop 1
  v_max_f32_dpp v57, v57, v57 row_ror:8 row_mask:0xf bank_mask:0xf
  v_mov_b32 v58, v57
  s_nop 1
  v_permlane16_swap_b32 v57, v58
  s_nop 1
  v_max_f32 v57, v57, v58
  v_mov_b32 v58, v57
  s_nop 1
  v_permlane32_swap_b32 v57, v58
  s_nop 1
  v_max_f32 v57, v57, v58
  v_exp_f32_e64 v59, -v57
  v_sub_f32 v5, v5, v57
  v_fma_f32 v12, v57, s68, v12
  v_mul_f32 v56, v56, v59
  v_mul_f32 v20, v20, v59
  v_mul_f32 v21, v21, v59
  v_mul_f32 v22, v22, v59
  v_mul_f32 v23, v23, v59
L_nors0:
  v_exp_f32 v6, v5
  s_nop 0
  v_cvt_pk_bf16_f32 v7, v6, v6
  v_add_f32 v56, v56, v6
  s_nop 0
  v_and_b32_dpp v40, v7, v8 row_newbcast:0 row_mask:0xf bank_mask:0xf
  v_and_b32_dpp v41, v7, v9 row_newbcast:0 row_mask:0xf bank_mask:0xf
  v_and_b32_dpp v42, v7, v10 row_newbcast:0 row_mask:0xf bank_mask:0xf
  v_and_b32_dpp v43, v7, v11 row_newbcast:0 row_mask:0xf bank_mask:0xf
  v_and_b32_dpp v44, v7, v8 row_newbcast:4 row_mask:0xf bank_mask:0xf
  v_and_b32_dpp v45, v7, v9 row_newbcast:4 row_mask:0xf bank_mask:0xf
  v_and_b32_dpp v46, v7, v10 row_newbcast:4 row_mask:0xf bank_mask:0xf
  v_and_b32_dpp v47, v7, v11 row_newbcast:4 row_mask:0xf bank_mask:0xf
  v_and_b32_dpp v48, v7, v8 row_newbcast:8 row_mask:0xf bank_mask:0xf
  v_and_b32_dpp v49, v7, v9 row_newbcast:8 row_mask:0xf bank_mask:0xf
  v_and_b32_dpp v50, v7, v10 row_newbcast:8 row_mask:0xf bank_mask:0xf
  v_and_b32_dpp v51, v7, v11 row_newbcast:8 row_mask:0xf bank_mask:0xf
  v_and_b32_dpp v52, v7, v8 row_newbcast:12 row_mask:0xf bank_mask:0xf
  v_and_b32_dpp v53, v7, v9 row_newbcast:12 row_mask:0xf bank_mask:0xf
  v_and_b32_dpp v54, v7, v10 row_newbcast:12 row_mask:0xf bank_mask:0xf
  v_and_b32_dpp v55, v7, v11 row_newbcast:12 row_mask:0xf bank_mask:0xf
  s_waitcnt vmcnt(6)
  buffer_load_dwordx4 a[12:15], v102, s[20:23], s53 offen offset:3072 nt
  v_mfma_f32_16x16x32_bf16 v[20:23], v[40:43], a[16:19], v[20:23]
  s_cmp_lg_u32 s57, 0
  s_cbranch_scc1 L_notk
  s_mov_b32 s54, 1
  s_atomic_add s54, s[18:19], s55 glc
L_notk:
  s_waitcnt vmcnt(6)
  buffer_load_dwordx4 a[16:19], v103, s[24:27], s53 offen offset:0 nt
  v_mfma_f32_16x16x32_bf16 v[20:23], v[44:47], a[20:23], v[20:23]
  s_waitcnt vmcnt(6)
  buffer_load_dwordx4 a[20:23], v103, s[24:27], s53 offen offset:1024 nt
  v_mfma_f32_16x16x32_bf16 v[20:23], v[48:51], a[24:27], v[20:23]
  s_waitcnt vmcnt(6)
  buffer_load_dwordx4 a[24:27], v103, s[24:27], s53 offen offset:2048 nt
  v_mfma_f32_16x16x32_bf16 v[20:23], v[52:55], a[28:31], v[20:23]
  s_mov_b32 s51, s53
  s_add_u32 s53, s53, 16384
  s_cmp_lg_u32 s57, 0
  s_cbranch_scc1 L_loop
  s_waitcnt lgkmcnt(0)
  s_lshr_b32 s47, s54, 3
  s_mov_b32 s57, s47
  s_mov_b32 s58, 1
  s_min_u32 s59, s47, 1
  s_addc_u32 s58, s58, 0
  s_add_u32 s57, s57, s59
  s_and_b32 s59, s54, 6
  s_lshl_b32 s59, s59, 6
  s_bitcmp1_b32 s54, 0
  s_cselect_b32 s47, 4, 0
  s_add_u32 s59, s59, s47
  s_add_u32 s59, s59, 120
  s_add_u32 s59, s59, s57
  s_lshl_b32 s59, s59, 14
  s_cmp_ge_u32 s57, 4
  s_cselect_b32 s57, 8388608, s59
  s_cselect_b32 s58, 0xff, s58
  s_or_b32 s57, s57, s58
  v_mov_b32 v60, s57
  ds_write_b32 v61, v60
  s_waitcnt lgkmcnt(0)
  s_branch L_loop
L_nopool:
  s_mul_i32 s57, s48, 163840
  s_lshl_b32 s58, s49, 8
  s_add_u32 s57, s57, s58
  buffer_load_dwordx4 v[64:67], v107, s[32:35], s57 offen offset:0 nt
  buffer_load_dwordx4 v[68:71], v107, s[32:35], s57 offen offset:1280 nt
  buffer_load_dwordx4 v[72:75], v107, s[32:35], s57 offen offset:2560 nt
  s_add_u32 s57, s57, 3840
  buffer_load_dwordx4 v[76:79], v107, s[32:35], s57 offen offset:0 nt
  buffer_load_dwordx4 v[80:83], v107, s[32:35], s57 offen offset:1280 nt
  buffer_load_dwordx4 v[84:87], v107, s[32:35], s57 offen offset:2560 nt
  s_add_u32 s57, s57, 3840
  buffer_load_dwordx4 v[88:91], v107, s[32:35], s57 offen offset:0 nt
  buffer_load_dwordx4 v[92:95], v107, s[32:35], s57 offen offset:1280 nt
  s_branch L_done
L_final:
  s_mul_i32 s57, s48, 163840
  s_lshl_b32 s58, s49, 8
  s_add_u32 s57, s57, s58
  s_add_u32 s58, s57, 3840
  s_add_u32 s54, s57, 7680
  s_waitcnt vmcnt(6)
  buffer_load_dwordx4 a[28:31], v103, s[24:27], s51 offen offset:3072 nt
  v_mfma_f32_16x16x32_bf16 v[16:19], a[0:3], v[24:27], v[12:15]
  s_waitcnt vmcnt(6)
  buffer_load_dwordx4 v[64:67], v107, s[32:35], s57 offen offset:0 nt
  v_mfma_f32_16x16x32_bf16 v[16:19], a[4:7], v[28:31], v[16:19]
  s_waitcnt vmcnt(6)
  buffer_load_dwordx4 v[68:71], v107, s[32:35], s57 offen offset:1280 nt
  v_mfma_f32_16x16x32_bf16 v[16:19], a[8:11], v[32:35], v[16:19]
  s_waitcnt vmcnt(6)
  buffer_load_dwordx4 v[72:75], v107, s[32:35], s57 offen offset:2560 nt
  v_mfma_f32_16x16x32_bf16 v[16:19], a[12:15], v[36:39], v[16:19]
  s_nop 7
  v_mul_f32_dpp v5, v16, v4 quad_perm:[0,0,0,0] row_mask:0xf bank_mask:0xf
  v_fmac_f32_dpp v5, v17, v4 quad_perm:[1,1,1,1] row_mask:0xf bank_mask:0xf
  v_fmac_f32_dpp v5, v18, v4 quad_perm:[2,2,2,2] row_mask:0xf bank_mask:0xf
  v_fmac_f32_dpp v5, v19, v4 quad_perm:[3,3,3,3] row_mask:0xf bank_mask:0xf
  v_cmp_lt_f32 vcc, 0, v5
  s_cbranch_vccz L_nors1
  v_max_f32_dpp v57, v5, v5 row_ror:4 row_mask:0xf bank_mask:0xf
  s_nop 1
  v_max_f32_dpp v57, v57, v57 row_ror:8 row_mask:0xf bank_mask:0xf
  v_mov_b32 v58, v57
  s_nop 1
  v_permlane16_swap_b32 v57, v58
  s_nop 1
  v_max_f32 v57, v57, v58
  v_mov_b32 v58, v57
  s_nop 1
  v_permlane32_swap_b32 v57, v58
  s_nop 1
  v_max_f32 v57, v57, v58
  v_exp_f32_e64 v59, -v57
  v_sub_f32 v5, v5, v57
  v_fma_f32 v12, v57, s68, v12
  v_mul_f32 v56, v56, v59
  v_mul_f32 v20, v20, v59
  v_mul_f32 v21, v21, v59
  v_mul_f32 v22, v22, v59
  v_mul_f32 v23, v23, v59
L_nors1:
  v_exp_f32 v6, v5
  s_nop 0
  v_cvt_pk_bf16_f32 v7, v6, v6
  v_add_f32 v56, v56, v6
  s_nop 0
  v_and_b32_dpp v40, v7, v8 row_newbcast:0 row_mask:0xf bank_mask:0xf
  v_and_b32_dpp v41, v7, v9 row_newbcast:0 row_mask:0xf bank_mask:0xf
  v_and_b32_dpp v42, v7, v10 row_newbcast:0 row_mask:0xf bank_mask:0xf
  v_and_b32_dpp v43, v7, v11 row_newbcast:0 row_mask:0xf bank_mask:0xf
  v_and_b32_dpp v44, v7, v8 row_newbcast:4 row_mask:0xf bank_mask:0xf
  v_and_b32_dpp v45, v7, v9 row_newbcast:4 row_mask:0xf bank_mask:0xf
  v_and_b32_dpp v46, v7, v10 row_newbcast:4 row_mask:0xf bank_mask:0xf
  v_and_b32_dpp v47, v7, v11 row_newbcast:4 row_mask:0xf bank_mask:0xf
  v_and_b32_dpp v48, v7, v8 row_newbcast:8 row_mask:0xf bank_mask:0xf
  v_and_b32_dpp v49, v7, v9 row_newbcast:8 row_mask:0xf bank_mask:0xf
  v_and_b32_dpp v50, v7, v10 row_newbcast:8 row_mask:0xf bank_mask:0xf
  v_and_b32_dpp v51, v7, v11 row_newbcast:8 row_mask:0xf bank_mask:0xf
  v_and_b32_dpp v52, v7, v8 row_newbcast:12 row_mask:0xf bank_mask:0xf
  v_and_b32_dpp v53, v7, v9 row_newbcast:12 row_mask:0xf bank_mask:0xf
  v_and_b32_dpp v54, v7, v10 row_newbcast:12 row_mask:0xf bank_mask:0xf
  v_and_b32_dpp v55, v7, v11 row_newbcast:12 row_mask:0xf bank_mask:0xf
  s_waitcnt vmcnt(6)
  buffer_load_dwordx4 v[76:79], v107, s[32:35], s58 offen offset:0 nt
  v_mfma_f32_16x16x32_bf16 v[20:23], v[40:43], a[16:19], v[20:23]
  s_waitcnt vmcnt(6)
  buffer_load_dwordx4 v[80:83], v107, s[32:35], s58 offen offset:1280 nt
  v_mfma_f32_16x16x32_bf16 v[20:23], v[44:47], a[20:23], v[20:23]
  s_waitcnt vmcnt(6)
  buffer_load_dwordx4 v[84:87], v107, s[32:35], s58 offen offset:2560 nt
  v_mfma_f32_16x16x32_bf16 v[20:23], v[48:51], a[24:27], v[20:23]
  s_waitcnt vmcnt(6)
  buffer_load_dwordx4 v[88:91], v107, s[32:35], s54 offen offset:0 nt
  v_mfma_f32_16x16x32_bf16 v[20:23], v[52:55], a[28:31], v[20:23]
  buffer_load_dwordx4 v[92:95], v107, s[32:35], s54 offen offset:1280 nt
  s_nop 1
L_done:
  v_add_f32_dpp v56, v56, v56 row_ror:4 row_mask:0xf bank_mask:0xf
  v_mul_f32 v104, s69, v12
  v_lshlrev_b32 v106, 4, v0
  v_add_f32_dpp v56, v56, v56 row_ror:8 row_mask:0xf bank_mask:0xf
  v_mov_b32 v58, v56
  v_lshlrev_b32 v107, 3, v101
  ds_write_b128 v106, v[20:23] offset:2048
  v_mul_u32_u24 v108, 640, v99
  v_permlane16_swap_b32 v56, v58
  v_add_u32 v109, 0x200, v108
  v_add_f32 v56, v56, v58
  v_mov_b32 v58, v56
  v_lshl_add_u32 v108, v101, 7, v108
  v_lshl_add_u32 v108, v100, 3, v108
  v_permlane32_swap_b32 v56, v58
  s_mov_b32 s59, 100000
  v_add_f32 v105, v56, v58
  ds_write_b64 v107, v[104:105] offset:6144
  s_cmp_lg_u32 s50, 0
  s_waitcnt lgkmcnt(0)
  s_barrier
  s_cbranch_scc1 L_hop1
  v_mov_b32 v107, 0
  ds_read_b128 v[112:115], v107 offset:6144
  ds_read_b128 v[116:119], v107 offset:6160
  ds_read_b128 v[28:31], v106 offset:3072
  ds_read_b128 v[32:35], v106 offset:4096
  ds_read_b128 v[36:39], v106 offset:5120
  s_mul_i32 s57, s49, 640
  s_add_u32 s57, s57, s70
  s_waitcnt lgkmcnt(3)
  v_max3_f32 v57, v112, v114, v116
  v_max_f32 v57, v57, v118
  v_bfi_b32 v57, v62, 0, v57
  v_sub_f32 v112, v112, v57
  v_sub_f32 v114, v114, v57
  v_sub_f32 v116, v116, v57
  v_sub_f32 v118, v118, v57
  v_exp_f32 v112, v112
  v_exp_f32 v114, v114
  v_exp_f32 v116, v116
  v_exp_f32 v118, v118
  v_mul_f32 v20, v112, v20
  v_mul_f32 v21, v112, v21
  v_mul_f32 v22, v112, v22
  v_mul_f32 v23, v112, v23
  v_mul_f32 v56, v112, v113
  v_fmac_f32 v56, v114, v115
  v_fmac_f32 v56, v116, v117
  v_fmac_f32 v56, v118, v119
  s_waitcnt lgkmcnt(0)
  v_fmac_f32 v20, v114, v28
  v_fmac_f32 v21, v114, v29
  v_fmac_f32 v22, v114, v30
  v_fmac_f32 v23, v114, v31
  v_fmac_f32 v20, v116, v32
  v_fmac_f32 v21, v116, v33
  v_fmac_f32 v22, v116, v34
  v_fmac_f32 v23, v116, v35
  v_fmac_f32 v20, v118, v36
  v_fmac_f32 v21, v118, v37
  v_fmac_f32 v22, v118, v38
  v_fmac_f32 v23, v118, v39
  v_cndmask_b32 v20, v20, v57, s[72:73]
  v_cndmask_b32 v21, v21, v56, s[72:73]
  v_cndmask_b32 v22, v22, 0, s[72:73]
  v_cndmask_b32 v23, v23, 0, s[72:73]
  v_bfi_b32 v20, v62, s40, v20
  v_bfi_b32 v21, v62, s40, v21
  v_bfi_b32 v22, v62, s40, v22
  v_bfi_b32 v23, v62, s40, v23
  buffer_store_dwordx4 v[20:23], v98, s[36:39], s57 offen sc1
L_hop1:
  s_cmp_ge_u32 s49, 5
  s_cbranch_scc1 L_fin
  v_mov_b32 v6, 1.0
  s_lshl_b32 s57, s49, 14
  s_lshl_b32 s58, s48, 9
  s_add_u32 s57, s57, s58
  s_add_u32 s58, s57, 589824
  s_add_u32 s57, s57, 327680
L_poll1:
  s_sleep 4
  buffer_load_dwordx4 v[116:119], v109, s[36:39], s70 offen sc1
  buffer_load_dwordx4 v[120:123], v109, s[36:39], s70 offen offset:2560 sc1
  buffer_load_dwordx2 v[112:113], v108, s[36:39], s70 offen sc1
  buffer_load_dwordx2 v[114:115], v108, s[36:39], s70 offen offset:2560 sc1
  s_sub_u32 s59, s59, 1
  s_waitcnt vmcnt(0)
  s_cbranch_scc1 L_got1
  v_xor_b32 v112, s40, v112
  v_xor_b32 v113, s40, v113
  v_xor_b32 v114, s40, v114
  v_xor_b32 v115, s40, v115
  v_xor_b32 v116, s40, v116
  v_xor_b32 v117, s40, v117
  v_xor_b32 v118, s40, v118
  v_xor_b32 v119, s40, v119
  v_xor_b32 v120, s40, v120
  v_xor_b32 v121, s40, v121
  v_xor_b32 v122, s40, v122
  v_xor_b32 v123, s40, v123
  v_or3_b32 v110, v112, v113, v114
  v_or3_b32 v110, v110, v115, v116
  v_or3_b32 v110, v110, v117, v120
  v_or_b32 v110, v110, v121
  v_and_b32 v110, v62, v110
  v_or3_b32 v110, v110, v118, v119
  v_or3_b32 v110, v110, v122, v123
  v_cmp_ne_u32 vcc, 0, v110
  s_cbranch_vccnz L_poll1
L_got1:
  v_max_f32 v57, v116, v120
  v_max_f32 v58, v116, v120
  s_nop 1
  v_permlane16_swap_b32 v57, v58
  s_nop 0
  v_max_f32 v59, v57, v58
  v_max_f32 v58, v57, v58
  s_nop 1
  v_permlane32_swap_b32 v59, v58
  s_nop 0
  v_max_f32 v57, v59, v58
  v_sub_f32 v116, v116, v57
  v_sub_f32 v120, v120, v57
  v_exp_f32 v116, v116
  v_exp_f32 v120, v120
  v_mul_f32 v117, v117, v116
  v_mul_f32 v112, v112, v116
  v_mul_f32 v113, v113, v116
  v_fmac_f32 v117, v121, v120
  v_fmac_f32 v112, v114, v120
  v_fmac_f32 v113, v115, v120
  v_mfma_f32_16x16x4_f32 v[24:27], v117, v6, 0
  v_mfma_f32_16x16x4_f32 v[28:31], v112, v6, 0
  v_mfma_f32_16x16x4_f32 v[32:35], v113, v6, 0
  s_nop 7
  v_rcp_f32 v59, v24
  s_nop 0
  v_mul_f32 v28, v28, v59
  v_mul_f32 v29, v29, v59
  v_mul_f32 v30, v30, v59
  v_mul_f32 v31, v31, v59
  v_mul_f32 v32, v32, v59
  v_mul_f32 v33, v33, v59
  v_mul_f32 v34, v34, v59
  v_mul_f32 v35, v35, v59
  v_cvt_pk_bf16_f32 v28, v28, v28
  v_cvt_pk_bf16_f32 v29, v29, v29
  v_cvt_pk_bf16_f32 v30, v30, v30
  v_cvt_pk_bf16_f32 v31, v31, v31
  v_cvt_pk_bf16_f32 v32, v32, v32
  v_cvt_pk_bf16_f32 v33, v33, v33
  v_cvt_pk_bf16_f32 v34, v34, v34
  v_cvt_pk_bf16_f32 v35, v35, v35
  v_and_b32 v40, v28, v8
  v_and_b32 v41, v28, v9
  v_and_b32 v42, v28, v10
  v_and_b32 v43, v28, v11
  v_and_b32 v44, v32, v8
  v_and_b32 v45, v32, v9
  v_and_b32 v46, v32, v10
  v_and_b32 v47, v32, v11
  v_mfma_f32_16x16x32_bf16 v[20:23], v[40:43], v[64:67], 0
  v_and_b32 v48, v29, v8
  v_and_b32 v49, v29, v9
  v_and_b32 v50, v29, v10
  v_and_b32 v51, v29, v11
  v_mfma_f32_16x16x32_bf16 v[20:23], v[44:47], v[68:71], v[20:23]
  v_and_b32 v52, v33, v8
  v_and_b32 v53, v33, v9
  v_and_b32 v54, v33, v10
  v_and_b32 v55, v33, v11
  v_mfma_f32_16x16x32_bf16 v[20:23], v[48:51], v[72:75], v[20:23]
  v_and_b32 v40, v30, v8
  v_and_b32 v41, v30, v9
  v_and_b32 v42, v30, v10
  v_and_b32 v43, v30, v11
  v_mfma_f32_16x16x32_bf16 v[20:23], v[52:55], v[76:79], v[20:23]
  v_and_b32 v44, v34, v8
  v_and_b32 v45, v34, v9
  v_and_b32 v46, v34, v10
  v_and_b32 v47, v34, v11
  v_mfma_f32_16x16x32_bf16 v[20:23], v[40:43], v[80:83], v[20:23]
  v_and_b32 v48, v31, v8
  v_and_b32 v49, v31, v9
  v_and_b32 v50, v31, v10
  v_and_b32 v51, v31, v11
  v_mfma_f32_16x16x32_bf16 v[20:23], v[44:47], v[84:87], v[20:23]
  v_and_b32 v52, v35, v8
  v_and_b32 v53, v35, v9
  v_and_b32 v54, v35, v10
  v_and_b32 v55, v35, v11
  v_mfma_f32_16x16x32_bf16 v[20:23], v[48:51], v[88:91], v[20:23]
  s_nop 1
  v_mfma_f32_16x16x32_bf16 v[20:23], v[52:55], v[92:95], v[20:23]
  s_cmp_lg_u32 s50, 0
  s_nop 6
  ds_write_b128 v106, v[20:23] offset:8192
  s_waitcnt lgkmcnt(0)
  s_barrier
  s_cbranch_scc1 L_hop2
  ds_read_b128 v[28:31], v106 offset:9216
  ds_read_b128 v[32:35], v106 offset:10240
  ds_read_b128 v[36:39], v106 offset:11264
  s_waitcnt lgkmcnt(2)
  v_add_f32 v20, v20, v28
  v_add_f32 v21, v21, v29
  v_add_f32 v22, v22, v30
  v_add_f32 v23, v23, v31
  s_waitcnt lgkmcnt(1)
  v_add_f32 v20, v20, v32
  v_add_f32 v21, v21, v33
  v_add_f32 v22, v22, v34
  v_add_f32 v23, v23, v35
  s_waitcnt lgkmcnt(0)
  v_add_f32 v20, v20, v36
  v_add_f32 v21, v21, v37
  v_add_f32 v22, v22, v38
  v_add_f32 v23, v23, v39
  v_bfi_b32 v20, v62, s40, v20
  v_bfi_b32 v21, v62, s40, v21
  v_bfi_b32 v22, v62, s40, v22
  v_bfi_b32 v23, v62, s40, v23
  buffer_store_dwordx4 v[20:23], v97, s[36:39], s57 offen
  buffer_store_dwordx4 v[20:23], v97, s[36:39], s58 offen sc1
L_hop2:
  s_cmp_lg_u32 s48, 0
  s_cbranch_scc1 L_fin
  v_lshrrev_b32 v104, 3, v1
  v_lshlrev_b32 v104, 9, v104
  v_lshl_add_u32 v104, v101, 7, v104
  v_and_b32 v105, 7, v1
  v_lshl_add_u32 v104, v105, 4, v104
  s_lshl_b32 s57, s49, 14
  s_add_u32 s57, s57, 327680
  s_add_u32 s58, s57, 4096
  s_add_u32 s53, s57, 8192
  s_add_u32 s54, s57, 12288
  s_mov_b32 s44, s14
  s_mov_b32 s45, s15
  s_mov_b32 s46, 1280
  s_mov_b32 s47, 0x20000
  v_lshlrev_b32 v106, 3, v105
  v_lshl_add_u32 v106, v101, 6, v106
  v_mov_b32 v107, 0x40000000
  v_cmp_gt_u32 vcc, 8, v1
  s_lshl_b32 s71, s49, 8
  v_or_b32 v110, s49, v0
  v_cndmask_b32 v106, v107, v106, vcc
  v_lshlrev_b32 v110, 22, v110
  v_mov_b32 v111, s3
  s_mov_b32 s56, 983040
  s_mov_b32 s59, 399999
  v_add_u32 v109, 262144, v104
  v_mov_b32 v112, v104
L_poll2:
  buffer_load_dwordx4 v[24:27], v112, s[36:39], s57 offen sc1
  buffer_load_dwordx4 v[28:31], v112, s[36:39], s58 offen sc1
  buffer_load_dwordx4 v[32:35], v112, s[36:39], s53 offen sc1
  buffer_load_dwordx4 v[36:39], v112, s[36:39], s54 offen sc1
  s_and_b32 s74, s59, 15
  s_cselect_b64 vcc, -1, 0
  v_cndmask_b32 v112, v109, v104, vcc
  s_sub_u32 s59, s59, 1
  s_waitcnt vmcnt(0)
  s_cbranch_scc1 L_got2
  v_xor_b32 v24, s40, v24
  v_xor_b32 v25, s40, v25
  v_xor_b32 v26, s40, v26
  v_xor_b32 v27, s40, v27
  v_xor_b32 v28, s40, v28
  v_xor_b32 v29, s40, v29
  v_xor_b32 v30, s40, v30
  v_xor_b32 v31, s40, v31
  v_xor_b32 v32, s40, v32
  v_xor_b32 v33, s40, v33
  v_xor_b32 v34, s40, v34
  v_xor_b32 v35, s40, v35
  v_xor_b32 v36, s40, v36
  v_xor_b32 v37, s40, v37
  v_xor_b32 v38, s40, v38
  v_xor_b32 v39, s40, v39
  v_or3_b32 v108, v24, v25, v26
  v_or3_b32 v108, v108, v27, v28
  v_or3_b32 v108, v108, v29, v30
  v_or3_b32 v108, v108, v31, v32
  v_or3_b32 v108, v108, v33, v34
  v_or3_b32 v108, v108, v35, v36
  v_or3_b32 v108, v108, v37, v38
  v_or_b32 v108, v108, v39
  v_and_b32 v108, v62, v108
  v_cmp_ne_u32 vcc, 0, v108
  s_cbranch_vccnz L_poll2
L_got2:
  v_add_f32 v24, v24, v28
  v_add_f32 v25, v25, v29
  v_add_f32 v26, v26, v30
  v_add_f32 v27, v27, v31
  v_add_f32 v32, v32, v36
  v_add_f32 v33, v33, v37
  v_add_f32 v34, v34, v38
  v_add_f32 v35, v35, v39
  v_add_f32 v24, v24, v32
  v_add_f32 v25, v25, v33
  v_add_f32 v26, v26, v34
  v_add_f32 v27, v27, v35
  v_add_f32_dpp v24, v24, v24 row_ror:8 row_mask:0xf bank_mask:0xf
  v_add_f32_dpp v25, v25, v25 row_ror:8 row_mask:0xf bank_mask:0xf
  v_add_f32_dpp v26, v26, v26 row_ror:8 row_mask:0xf bank_mask:0xf
  v_add_f32_dpp v27, v27, v27 row_ror:8 row_mask:0xf bank_mask:0xf
  v_mov_b32 v28, v24
  v_mov_b32 v29, v25
  v_mov_b32 v30, v26
  v_mov_b32 v31, v27
  v_permlane16_swap_b32 v24, v28
  v_permlane16_swap_b32 v25, v29
  v_permlane16_swap_b32 v26, v30
  v_permlane16_swap_b32 v27, v31
  v_add_f32 v24, v24, v28
  v_add_f32 v25, v25, v29
  v_add_f32 v26, v26, v30
  v_add_f32 v27, v27, v31
  v_mov_b32 v28, v24
  v_mov_b32 v29, v25
  v_mov_b32 v30, v26
  v_mov_b32 v31, v27
  v_permlane32_swap_b32 v24, v28
  v_permlane32_swap_b32 v25, v29
  v_permlane32_swap_b32 v26, v30
  v_permlane32_swap_b32 v27, v31
  v_add_f32 v24, v24, v28
  v_add_f32 v25, v25, v29
  v_add_f32 v26, v26, v30
  v_add_f32 v27, v27, v31
  v_cvt_pk_bf16_f32 v32, v24, v25
  v_cvt_pk_bf16_f32 v33, v26, v27
  buffer_store_dwordx2 v[32:33], v106, s[44:47], s71 offen
  buffer_store_dword v111, v110, s[36:39], s56 offen
L_fin:
L_end:
  s_endpgm
.section .rodata,"a"
.p2align 6
.amdhsa_kernel standalone__gqa_block_cached__decode_kernel
  .amdhsa_next_free_vgpr 272
  .amdhsa_next_free_sgpr 102
  .amdhsa_accum_offset 128
  .amdhsa_group_segment_fixed_size 0
  .amdhsa_kernarg_size 64
  .amdhsa_user_sgpr_count 2
  .amdhsa_user_sgpr_kernarg_segment_ptr 1
  .amdhsa_system_sgpr_workgroup_id_x 1
  .amdhsa_float_denorm_mode_32 3
.end_amdhsa_kernel
```
